```python
import torch

def _softmax(x, axis=-1):
    return torch.softmax(x, dim=axis)
def _gelu(x):
    return torch.nn.functional.gelu(x, approximate="tanh")
def _silu(x):
    return torch.nn.functional.silu(x)
def _sigmoid(x):
    return torch.sigmoid(x)
def _layernorm(x, axis=-1, eps=1e-5):
    m = x.mean(dim=axis, keepdim=True)
    v = x.var(dim=axis, keepdim=True, unbiased=False)
    return (x - m) / torch.sqrt(v + eps)
def _scatter_add(tgt, idx, src, axis=0):
    return tgt.clone().index_add_(axis, idx, src)
def _segment_sum(src, seg, n):
    out = torch.zeros((n,) + src.shape[1:], dtype=src.dtype)
    return out.index_add_(0, seg, src)
def _pad(x, pw):
    flat = tuple(v for pair in reversed(pw) for v in pair)
    return torch.nn.functional.pad(x, flat)

kernel_name = 'parallel_sum__ssm_conv_h3__dense_activation_squared_relu__prompt'

def setup_inputs():

    _w = (lambda a: (lambda t: t.to(torch.bfloat16) if t.is_floating_point() else t)(torch.as_tensor(a)))
    def _A_setup():
        B, S, D = 1, 2048, 512
        ks = 4
        return {
            "q": _w((lambda *s: torch.randn(*s, dtype=torch.bfloat16) * 0.05)(B, S, D)),
            "k": _w((lambda *s: torch.randn(*s, dtype=torch.bfloat16) * 0.8)(B, S, D)),
            "v": _w((lambda *s: torch.randn(*s, dtype=torch.bfloat16) * 0.8)(B, S, D)),
            "shift_k": _w((lambda *s: torch.randn(*s, dtype=torch.bfloat16) * 0.8)(D, ks) * 0.5),
            "ssm_k": _w((lambda *s: torch.randn(*s, dtype=torch.bfloat16) * 0.8)(D, S) * (1.0 / S ** 0.5)),
            "ssm_D": _w((lambda *s: torch.randn(*s, dtype=torch.bfloat16) * 0.8)(D)),
        }
    _A_in = _A_setup()

    def _B_setup():
        B, S, D, F = 1, 2048, 512, 1792
        return {
            "x": _w((lambda *s: torch.randn(*s, dtype=torch.bfloat16) * 0.05)(B, S, D)),
            "w1": _w((lambda *s: torch.randn(*s, dtype=torch.bfloat16) * 0.05)(D, F)),
            "b1": _w((lambda *s: torch.randn(*s, dtype=torch.bfloat16) * 0.2)(F)),
            "w2": _w((lambda *s: torch.randn(*s, dtype=torch.bfloat16) * 0.05)(F, D)),
            "b2": _w((lambda *s: torch.randn(*s, dtype=torch.bfloat16) * 1.6)(D)),
        }
    _B_in = _B_setup()

    return {
        "A_q": _A_in["q"],
        "A_k": _A_in["k"],
        "A_v": _A_in["v"],
        "A_shift_k": _A_in["shift_k"],
        "A_ssm_k": _A_in["ssm_k"],
        "A_ssm_D": _A_in["ssm_D"],
        "B_x": _B_in["x"],
        "B_w1": _B_in["w1"],
        "B_b1": _B_in["b1"],
        "B_w2": _B_in["w2"],
        "B_b2": _B_in["b2"],
    }

def reference(A_q, A_k, A_v, A_shift_k, A_ssm_k, A_ssm_D, B_x, B_w1, B_b1, B_w2, B_b2):
    def _A_ref(q, k, v, shift_k, ssm_k, ssm_D):
        B, S, D = q.shape
        ks = shift_k.shape[-1]
        k_pad = _pad(k, ((0, 0), (ks - 1, 0), (0, 0)))
        k_shift = torch.zeros_like(k)
        for t in range(ks):
            k_shift = k_shift + k_pad[:, t:t + S, :] * shift_k[:, ks - 1 - t][None, None, :]
        kv = k_shift * v
        L = 2 * S
        kv_pad = _pad(kv, ((0, 0), (0, S), (0, 0)))
        kf_pad = _pad(ssm_k, ((0, 0), (0, S)))
        kv_f = (lambda x, axes=(-2,-1): torch.fft.rfft2(x.float(), dim=axes))(kv_pad[:, None, :, :], axes=(1, 2))
        kf_f = (lambda x, axes=(-2,-1): torch.fft.rfft2(x.float(), dim=axes))(kf_pad[:, None, :], axes=(1, 2))
        kf_f = (lambda x, *d: x.permute(*d))(kf_f, 1, 2, 0)
        y_f = kv_f * kf_f[None, :, :, :]
        y = (lambda x, s, axes=(-2,-1): torch.fft.irfft2(x, s=s, dim=axes).to(torch.bfloat16))(y_f, (1, L), axes=(1, 2))[:, 0, :S, :]
        y = y + kv * ssm_D[None, None, :]
        return q * y

    def _B_ref(x, w1, b1, w2, b2):
        h = torch.einsum("bsd,df->bsf", x, w1) + b1
        zero = torch.zeros_like(h)
        r = torch.where(h > zero, h, zero)
        h = r * r
        out = torch.einsum("bsf,fd->bsd", h, w2) + b2
        return out

    x = A_q
    xn = _layernorm(x, axis=-1)
    return x + _A_ref(xn, A_k, A_v, A_shift_k, A_ssm_k, A_ssm_D) + _B_ref(xn, B_w1, B_b1, B_w2, B_b2)
```

```asm
; @launch grid=(256,1,1) block=(256,1,1) lds=163840
.amdgcn_target "amdgcn-amd-amdhsa--gfx950"
.text
.globl parallel_sum__ssm_conv_h3__dense_activation_squared_relu__prompt_kernel
.p2align 8
.type parallel_sum__ssm_conv_h3__dense_activation_squared_relu__prompt_kernel,@function
parallel_sum__ssm_conv_h3__dense_activation_squared_relu__prompt_kernel:
  s_cmp_ge_u32 s2, 256
  s_cbranch_scc1 fz_end
  s_memrealtime s[86:87]
  s_load_dwordx16 s[4:19], s[0:1], 0
  s_load_dwordx8 s[20:27], s[0:1], 64
  s_load_dwordx4 s[28:31], s[0:1], 96
  v_and_b32 v1, 63, v0
  v_lshrrev_b32 v2, 6, v0
  s_and_b32 s33, s2, 7
  s_lshr_b32 s34, s2, 3
  v_readfirstlane_b32 s35, v2
  v_mov_b32 v253, 0
  s_getpc_b64 s[76:77]
Lct1:
  s_sub_u32 s76, s76, Lct1-parallel_sum__ssm_conv_h3__dense_activation_squared_relu__prompt_kernel
  s_subb_u32 s77, s77, 0
  s_lshl_b32 s83, s34, 2
  s_add_u32 s83, s83, s35
  v_lshlrev_b32 v14, 7, v1
  v_add_u32 v14, s83, v14
  v_lshlrev_b32 v14, 7, v14
  v_min_u32 v14, fz_end-parallel_sum__ssm_conv_h3__dense_activation_squared_relu__prompt_kernel-4, v14
  v_mov_b32 v15, s77
  v_add_co_u32 v14, vcc, s76, v14
  s_nop 1
  v_addc_co_u32 v15, vcc, 0, v15, vcc
  s_mov_b64 exec, 7
  global_load_dword v186, v[14:15], off
  s_mov_b64 exec, -1
  v_and_b32 v11, 31, v1
  v_lshlrev_b32 v11, 4, v11
  v_and_b32 v3, 7, v1
  v_lshrrev_b32 v4, 3, v1
  s_lshl_b32 s36, s34, 6
  s_lshl_b32 s37, s35, 4
  s_add_u32 s36, s36, s37
  s_lshl_b32 s36, s36, 10
  s_lshl_b32 s37, s33, 7
  s_add_u32 s36, s36, s37
  v_lshlrev_b32 v5, 11, v4
  v_lshl_add_u32 v5, v3, 4, v5
  v_add_u32 v5, s36, v5
  v_add_u32 v6, -3072, v5
  v_add_u32 v7, -2048, v5
  v_add_u32 v8, -1024, v5
  v_add_u32 v9, 0, v5
  v_add_u32 v10, 1024, v5
  s_lshl_b32 s39, s33, 9
  s_lshl_b32 s36, s2, 2
  s_add_u32 s78, s36, s35
  s_waitcnt lgkmcnt(0)
  s_mov_b32 s40, s6
  s_mov_b32 s41, s7
  s_mov_b32 s42, 0x200000
  s_mov_b32 s43, 0x20000
  buffer_load_dwordx4 v[16:19], v6, s[40:43], 0 offen
  buffer_load_dwordx4 v[20:23], v7, s[40:43], 0 offen
  buffer_load_dwordx4 v[24:27], v8, s[40:43], 0 offen
  buffer_load_dwordx4 v[28:31], v9, s[40:43], 0 offen
  buffer_load_dwordx4 v[32:35], v10, s[40:43], 0 offen
  s_mov_b32 s44, s8
  s_mov_b32 s45, s9
  s_mov_b32 s46, 0x200000
  s_mov_b32 s47, 0x20000
  buffer_load_dwordx4 v[36:39], v5, s[44:47], 0 offen
  buffer_load_dwordx4 v[40:43], v5, s[44:47], 0 offen offset:1024
  s_mov_b32 s48, s10
  s_mov_b32 s49, s11
  s_mov_b32 s50, 0x1000
  s_mov_b32 s51, 0x20000
  buffer_load_dwordx4 v[44:47], v11, s[48:51], s39 offen
  s_mul_i32 s36, s34, 37
  s_lshr_b32 s36, s36, 8
  s_mul_i32 s37, s36, 7
  s_sub_u32 s37, s34, s37
  s_lshr_b32 s38, s33, 1
  s_lshl_b32 s38, s38, 2
  s_add_u32 s73, s38, s36
  s_and_b32 s38, s33, 1
  s_mul_i32 s38, s38, 7
  s_add_u32 s74, s38, s37
  s_mov_b32 s52, s4
  s_mov_b32 s53, s5
  s_mov_b32 s54, 0x200000
  s_mov_b32 s55, 0x20000
  s_mov_b32 s56, s18
  s_mov_b32 s57, s19
  s_mov_b32 s58, 0x1c0000
  s_mov_b32 s59, 0x20000
  s_mov_b32 s92, s28
  s_mov_b32 s93, s29
  s_mov_b32 s94, 0x100
  s_mov_b32 s95, 0x20000
  s_cmp_eq_u32 s78, 992
  s_cbranch_scc0 fz_n0
  v_mov_b32 v250, s86
  v_mov_b32 v251, 1
  s_mov_b64 exec, 1
  buffer_store_dwordx2 v[250:251], v253, s[92:95], 0 offen sc1
  s_mov_b64 exec, -1
fz_n0:
  s_cmp_ge_u32 s34, 28
  s_cbranch_scc1 fz_spare
  v_lshrrev_b32 v10, 3, v1
  v_and_b32 v11, 7, v1
  v_lshrrev_b32 v12, 1, v10
  v_add_u32 v13, 0, v12
  v_xor_b32 v13, v13, v11
  v_lshlrev_b32 v13, 4, v13
  v_lshl_add_u32 v13, v10, 10, v13
  v_add_u32 v192, 0, v13
  v_add_u32 v13, 4, v12
  v_xor_b32 v13, v13, v11
  v_lshlrev_b32 v13, 4, v13
  v_lshl_add_u32 v13, v10, 10, v13
  v_add_u32 v193, 7168, v13
  v_add_u32 v13, 0, v12
  v_xor_b32 v13, v13, v11
  v_lshlrev_b32 v13, 4, v13
  v_lshl_add_u32 v13, v10, 10, v13
  v_add_u32 v194, 14336, v13
  v_add_u32 v13, 4, v12
  v_xor_b32 v13, v13, v11
  v_lshlrev_b32 v13, 4, v13
  v_lshl_add_u32 v13, v10, 10, v13
  v_add_u32 v195, 21504, v13
  v_lshrrev_b32 v10, 4, v1
  v_and_b32 v11, 15, v1
  v_lshlrev_b32 v12, 2, v10
  v_xor_b32 v12, v12, v11
  v_lshlrev_b32 v12, 4, v12
  v_mul_u32_u24 v13, 3584, v10
  v_add_u32 v13, v13, v12
  v_add_u32 v196, 0, v13
  v_add_u32 v197, 13312, v13
  v_add_u32 v198, 26624, v13
  v_add_u32 v199, 39936, v13
  s_lshl_b32 s80, s73, 17
  s_lshl_b32 s36, s35, 15
  s_add_u32 s80, s80, s36
  s_mul_i32 s81, s35, 57344
  s_lshl_b32 s36, s74, 8
  s_add_u32 s81, s81, s36
  s_lshl_b32 s82, s35, 12
  s_add_u32 m0, s82, 0
  s_nop 0
  buffer_load_dwordx4 v192, s[52:55], s80 offen offset:0 lds
  buffer_load_dwordx4 v193, s[52:55], s80 offen offset:1024 lds
  buffer_load_dwordx4 v194, s[52:55], s80 offen offset:2048 lds
  buffer_load_dwordx4 v195, s[52:55], s80 offen offset:3072 lds
  s_add_u32 m0, s82, 16384
  s_nop 0
  buffer_load_dwordx4 v196, s[56:59], s81 offen offset:0 lds
  buffer_load_dwordx4 v197, s[56:59], s81 offen offset:1024 lds
  buffer_load_dwordx4 v198, s[56:59], s81 offen offset:2048 lds
  buffer_load_dwordx4 v199, s[56:59], s81 offen offset:3072 lds
  s_add_u32 s80, s80, 128
  s_add_u32 s81, s81, 229376
  s_add_u32 s96, s30, 0xe00000
  s_addc_u32 s97, s31, 0
  s_mov_b32 s98, 0x48000
  s_mov_b32 s99, 0x20000
  s_add_u32 s60, s30, 0x800000
  s_addc_u32 s61, s31, 0
  s_mov_b32 s62, 0x200000
  s_mov_b32 s63, 0x20000
  s_add_u32 s64, s30, 0xc60000
  s_addc_u32 s65, s31, 0
  s_mov_b32 s66, 0x8000
  s_mov_b32 s67, 0x20000
  s_add_u32 s68, s30, 0xc10000
  s_addc_u32 s69, s31, 0
  s_mov_b32 s70, 0x38000
  s_mov_b32 s71, 0x20000
  s_mov_b32 s40, s20
  s_mov_b32 s41, s21
  s_mov_b32 s42, 0xe00
  s_mov_b32 s43, 0x20000
  s_mov_b32 s8, s22
  s_mov_b32 s9, s23
  s_mov_b32 s10, 0x1c0000
  s_mov_b32 s11, 0x20000
  s_lshl_b32 s17, s35, 11
  v_and_b32 v10, 31, v1
  v_lshrrev_b32 v11, 5, v1
  v_lshrrev_b32 v12, 1, v10
  v_and_b32 v12, 7, v12
  v_xor_b32 v12, v12, v11
  s_lshr_b32 s37, s35, 1
  s_lshl_b32 s37, s37, 13
  v_lshlrev_b32 v13, 7, v10
  v_add_u32 v13, s37, v13
  v_xor_b32 v14, 0, v12
  v_lshl_add_u32 v200, v14, 4, v13
  v_add_u32 v204, 0x10000, v200
  v_xor_b32 v14, 2, v12
  v_lshl_add_u32 v201, v14, 4, v13
  v_add_u32 v205, 0x10000, v201
  v_xor_b32 v14, 4, v12
  v_lshl_add_u32 v202, v14, 4, v13
  v_add_u32 v206, 0x10000, v202
  v_xor_b32 v14, 6, v12
  v_lshl_add_u32 v203, v14, 4, v13
  v_add_u32 v207, 0x10000, v203
  v_and_b32 v10, 15, v1
  v_lshrrev_b32 v11, 4, v1
  v_lshrrev_b32 v12, 1, v11
  v_and_b32 v11, 1, v11
  v_lshrrev_b32 v13, 2, v10
  v_lshl_add_u32 v12, v12, 3, v13
  v_lshlrev_b32 v12, 8, v12
  v_and_b32 v14, 1, v10
  v_lshl_add_u32 v12, v14, 3, v12
  v_add_u32 v12, 16384, v12
  v_and_b32 v14, 3, v10
  v_lshrrev_b32 v14, 1, v14
  v_lshl_add_u32 v14, v11, 1, v14
  s_and_b32 s37, s35, 1
  s_lshl_b32 s37, s37, 3
  v_add_u32 v14, s37, v14
  v_lshlrev_b32 v13, 2, v13
  v_add_u32 v15, 0, v14
  v_xor_b32 v15, v15, v13
  v_lshl_add_u32 v208, v15, 4, v12
  v_add_u32 v210, 0x10000, v208
  v_add_u32 v15, 4, v14
  v_xor_b32 v15, v15, v13
  v_lshl_add_u32 v209, v15, 4, v12
  v_add_u32 v211, 0x10000, v209
  s_lshr_b32 s89, s33, 1
  s_lshl_b32 s89, s89, 9
  s_lshr_b32 s36, s34, 2
  s_lshl_b32 s36, s36, 6
  s_add_u32 s89, s89, s36
  s_and_b32 s90, s33, 1
  s_lshl_b32 s90, s90, 2
  s_and_b32 s36, s34, 3
  s_add_u32 s90, s90, s36
  s_lshl_b32 s90, s90, 6
  s_lshr_b32 s36, s89, 5
  s_mul_i32 s36, s36, 112
  s_mul_i32 s37, s35, 28
  s_add_u32 s36, s36, s37
  s_lshl_b32 s91, s36, 10
  s_lshl_b32 s3, s37, 14
  s_lshl_b32 s36, s90, 1
  s_add_u32 s3, s3, s36
  v_lshlrev_b32 v244, 4, v1
  v_add_u32 v245, 114688, v244
  v_lshrrev_b32 v10, 3, v1
  v_and_b32 v11, 7, v1
  v_lshrrev_b32 v12, 1, v10
  v_and_b32 v12, 1, v12
  v_lshlrev_b32 v12, 2, v12
  v_xor_b32 v12, v12, v11
  v_lshlrev_b32 v12, 4, v12
  v_lshl_add_u32 v246, v10, 10, v12
  v_add_u32 v247, 7168, v246
  s_lshl_b32 s36, s35, 9
  s_add_u32 m0, s82, 32768
  s_nop 0
  buffer_load_dwordx4 v192, s[52:55], s80 offen offset:0 lds
  s_add_u32 s36, s36, 139264
  v_and_b32 v11, 31, v1
  v_lshlrev_b32 v11, 4, v11
  v_add_u32 v11, s36, v11
  v_lshlrev_b32 v2, 6, v3
  v_add_u32 v2, s36, v2
  s_waitcnt vmcnt(9)
  ds_write_b128 v11, v[44:47]
  s_lshl_b32 s36, s35, 3
  s_sub_u32 s36, 31, s36
  buffer_load_dwordx4 v193, s[52:55], s80 offen offset:1024 lds
  v_sub_u32 v15, s36, v4
  v_lshrrev_b32 v6, 2, v15
  v_xor_b32 v6, v6, v3
  v_and_b32 v15, 3, v15
  v_lshlrev_b32 v15, 2, v15
  v_lshl_add_u32 v15, v6, 4, v15
  v_lshl_add_u32 v15, v3, 10, v15
  v_add_u32 v15, 131072, v15
  s_waitcnt lgkmcnt(0)
  buffer_load_dwordx4 v194, s[52:55], s80 offen offset:2048 lds
  ds_read_b128 v[44:47], v2 offset:0
  ds_read_b128 v[48:51], v2 offset:16
  ds_read_b128 v[52:55], v2 offset:32
  ds_read_b128 v[56:59], v2 offset:48
  s_mov_b32 s76, 0x05040100
  s_mov_b32 s77, 0x07060302
  v_perm_b32 v108, v24, v28, s76
  v_perm_b32 v109, v16, v20, s76
  v_perm_b32 v110, v28, v32, s76
  v_perm_b32 v111, v20, v24, s76
  buffer_load_dwordx4 v195, s[52:55], s80 offen offset:3072 lds
  s_waitcnt lgkmcnt(3)
  v_dot2_f32_bf16 v112, v108, v44, 0
  v_dot2_f32_bf16 v113, v110, v44, 0
  v_lshlrev_b32 v114, 16, v36
  v_lshlrev_b32 v115, 16, v40
  v_dot2_f32_bf16 v112, v109, v45, v112
  v_dot2_f32_bf16 v113, v111, v45, v113
  v_perm_b32 v116, v24, v28, s77
  v_perm_b32 v117, v16, v20, s77
  v_perm_b32 v118, v28, v32, s77
  s_add_u32 m0, s82, 49152
  s_nop 0
  buffer_load_dwordx4 v196, s[56:59], s81 offen offset:0 lds
  v_perm_b32 v119, v20, v24, s77
  v_dot2_f32_bf16 v120, v116, v46, 0
  v_dot2_f32_bf16 v121, v118, v46, 0
  v_and_b32 v122, 0xffff0000, v36
  v_and_b32 v123, 0xffff0000, v40
  v_dot2_f32_bf16 v120, v117, v47, v120
  v_dot2_f32_bf16 v121, v119, v47, v121
  v_mul_f32 v112, v112, v114
  v_mul_f32 v113, v113, v115
  buffer_load_dwordx4 v197, s[56:59], s81 offen offset:1024 lds
  v_cvt_pk_bf16_f32 v100, v113, v112
  ds_write_b32 v15, v100 offset:0
  v_perm_b32 v108, v25, v29, s76
  v_perm_b32 v109, v17, v21, s76
  v_perm_b32 v110, v29, v33, s76
  v_perm_b32 v111, v21, v25, s76
  s_waitcnt lgkmcnt(3)
  v_dot2_f32_bf16 v112, v108, v48, 0
  v_dot2_f32_bf16 v113, v110, v48, 0
  v_lshlrev_b32 v114, 16, v37
  v_lshlrev_b32 v115, 16, v41
  buffer_load_dwordx4 v198, s[56:59], s81 offen offset:2048 lds
  v_dot2_f32_bf16 v112, v109, v49, v112
  v_dot2_f32_bf16 v113, v111, v49, v113
  v_mul_f32 v120, v120, v122
  v_mul_f32 v121, v121, v123
  v_cvt_pk_bf16_f32 v101, v121, v120
  ds_write_b32 v15, v101 offset:128
  v_perm_b32 v116, v25, v29, s77
  v_perm_b32 v117, v17, v21, s77
  v_perm_b32 v118, v29, v33, s77
  buffer_load_dwordx4 v199, s[56:59], s81 offen offset:3072 lds
  s_add_u32 s80, s80, 128
  s_add_u32 s81, s81, 229376
  v_perm_b32 v119, v21, v25, s77
  v_dot2_f32_bf16 v120, v116, v50, 0
  v_dot2_f32_bf16 v121, v118, v50, 0
  v_and_b32 v122, 0xffff0000, v37
  v_and_b32 v123, 0xffff0000, v41
  v_dot2_f32_bf16 v120, v117, v51, v120
  v_dot2_f32_bf16 v121, v119, v51, v121
  v_mul_f32 v112, v112, v114
  v_mul_f32 v113, v113, v115
  v_cvt_pk_bf16_f32 v102, v113, v112
  s_add_u32 m0, s82, 65536
  s_nop 0
  buffer_load_dwordx4 v192, s[52:55], s80 offen offset:0 lds
  ds_write_b32 v15, v102 offset:256
  v_perm_b32 v108, v26, v30, s76
  v_perm_b32 v109, v18, v22, s76
  v_perm_b32 v110, v30, v34, s76
  v_perm_b32 v111, v22, v26, s76
  s_waitcnt lgkmcnt(4)
  v_dot2_f32_bf16 v112, v108, v52, 0
  v_dot2_f32_bf16 v113, v110, v52, 0
  v_lshlrev_b32 v114, 16, v38
  v_lshlrev_b32 v115, 16, v42
  buffer_load_dwordx4 v193, s[52:55], s80 offen offset:1024 lds
  v_dot2_f32_bf16 v112, v109, v53, v112
  v_dot2_f32_bf16 v113, v111, v53, v113
  v_mul_f32 v120, v120, v122
  v_mul_f32 v121, v121, v123
  v_cvt_pk_bf16_f32 v103, v121, v120
  ds_write_b32 v15, v103 offset:384
  v_perm_b32 v116, v26, v30, s77
  v_perm_b32 v117, v18, v22, s77
  v_perm_b32 v118, v30, v34, s77
  buffer_load_dwordx4 v194, s[52:55], s80 offen offset:2048 lds
  v_perm_b32 v119, v22, v26, s77
  v_dot2_f32_bf16 v120, v116, v54, 0
  v_dot2_f32_bf16 v121, v118, v54, 0
  v_and_b32 v122, 0xffff0000, v38
  v_and_b32 v123, 0xffff0000, v42
  v_dot2_f32_bf16 v120, v117, v55, v120
  v_dot2_f32_bf16 v121, v119, v55, v121
  v_mul_f32 v112, v112, v114
  v_mul_f32 v113, v113, v115
  v_cvt_pk_bf16_f32 v104, v113, v112
  buffer_load_dwordx4 v195, s[52:55], s80 offen offset:3072 lds
  ds_write_b32 v15, v104 offset:512
  v_perm_b32 v108, v27, v31, s76
  v_perm_b32 v109, v19, v23, s76
  v_perm_b32 v110, v31, v35, s76
  v_perm_b32 v111, v23, v27, s76
  s_waitcnt lgkmcnt(5)
  v_dot2_f32_bf16 v112, v108, v56, 0
  v_dot2_f32_bf16 v113, v110, v56, 0
  v_lshlrev_b32 v114, 16, v39
  v_lshlrev_b32 v115, 16, v43
  s_add_u32 m0, s82, 81920
  s_nop 0
  buffer_load_dwordx4 v196, s[56:59], s81 offen offset:0 lds
  v_dot2_f32_bf16 v112, v109, v57, v112
  v_dot2_f32_bf16 v113, v111, v57, v113
  v_mul_f32 v120, v120, v122
  v_mul_f32 v121, v121, v123
  v_cvt_pk_bf16_f32 v105, v121, v120
  ds_write_b32 v15, v105 offset:640
  v_perm_b32 v116, v27, v31, s77
  v_perm_b32 v117, v19, v23, s77
  v_perm_b32 v118, v31, v35, s77
  buffer_load_dwordx4 v197, s[56:59], s81 offen offset:1024 lds
  v_perm_b32 v119, v23, v27, s77
  v_dot2_f32_bf16 v120, v116, v58, 0
  v_dot2_f32_bf16 v121, v118, v58, 0
  v_and_b32 v122, 0xffff0000, v39
  v_and_b32 v123, 0xffff0000, v43
  v_dot2_f32_bf16 v120, v117, v59, v120
  v_dot2_f32_bf16 v121, v119, v59, v121
  v_mul_f32 v112, v112, v114
  v_mul_f32 v113, v113, v115
  v_cvt_pk_bf16_f32 v106, v113, v112
  buffer_load_dwordx4 v198, s[56:59], s81 offen offset:2048 lds
  ds_write_b32 v15, v106 offset:768
  s_lshl_b32 s36, s35, 4
  v_add_u32 v6, s36, v4
  v_mul_f32 v120, v120, v122
  v_mul_f32 v121, v121, v123
  v_cvt_pk_bf16_f32 v107, v121, v120
  ds_write_b32 v15, v107 offset:896
  v_lshlrev_b32 v7, 7, v6
  v_lshl_add_u32 v7, v3, 4, v7
  buffer_load_dwordx4 v199, s[56:59], s81 offen offset:3072 lds
  s_add_u32 s80, s80, 128
  s_add_u32 s81, s81, 229376
  v_add_u32 v24, 131072, v7
  v_lshlrev_b32 v8, 12, v6
  s_lshl_b32 s37, s35, 1
  v_xor_b32 v9, s37, v3
  v_lshl_add_u32 v25, v9, 4, v8
  s_add_u32 s37, s37, 1
  v_xor_b32 v10, s37, v3
  v_lshl_add_u32 v10, v10, 4, v8
  v_add_u32 v26, 0x8000, v10
  s_waitcnt vmcnt(16)
  s_waitcnt lgkmcnt(0)
  s_barrier
  ds_read_b64_tr_b16 v[32:33], v208 offset:0
  ds_read_b64_tr_b16 v[34:35], v208 offset:1024
  ds_read_b64_tr_b16 v[36:37], v209 offset:0
  ds_read_b64_tr_b16 v[38:39], v209 offset:1024
  ds_read_b128 v[40:43], v200 offset:0
  ds_read_b128 v[44:47], v200 offset:4096
  s_waitcnt lgkmcnt(1)
  v_mfma_f32_32x32x16_bf16 v[64:79], v[32:35], v[40:43], 0
  ds_read_b64_tr_b16 v[48:49], v208 offset:4096
  ds_read_b64_tr_b16 v[50:51], v208 offset:5120
  s_add_u32 m0, s82, 98304
  s_nop 0
  buffer_load_dwordx4 v192, s[52:55], s80 offen offset:0 lds
  ds_read_b128 v[16:19], v24
  s_waitcnt lgkmcnt(3)
  v_mfma_f32_32x32x16_bf16 v[80:95], v[32:35], v[44:47], 0
  ds_read_b64_tr_b16 v[52:53], v209 offset:4096
  ds_read_b64_tr_b16 v[54:55], v209 offset:5120
  buffer_load_dwordx4 v193, s[52:55], s80 offen offset:1024 lds
  ds_read_b128 v[20:23], v24 offset:1024
  v_mfma_f32_32x32x16_bf16 v[96:111], v[36:39], v[40:43], 0
  ds_read_b128 v[56:59], v201 offset:0
  ds_read_b128 v[60:63], v201 offset:4096
  s_lshl_b32 s83, s33, 18
  v_mfma_f32_32x32x16_bf16 v[112:127], v[36:39], v[44:47], 0
  buffer_load_dwordx4 v194, s[52:55], s80 offen offset:2048 lds
  s_lshl_b32 s84, s34, 7
  s_waitcnt lgkmcnt(1)
  v_mfma_f32_32x32x16_bf16 v[64:79], v[48:51], v[56:59], v[64:79]
  ds_read_b64_tr_b16 v[32:33], v208 offset:8192
  ds_read_b64_tr_b16 v[34:35], v208 offset:9216
  buffer_load_dwordx4 v195, s[52:55], s80 offen offset:3072 lds
  s_sub_u32 s83, s83, s84
  s_waitcnt lgkmcnt(2)
  v_mfma_f32_32x32x16_bf16 v[80:95], v[48:51], v[60:63], v[80:95]
  ds_read_b64_tr_b16 v[36:37], v209 offset:8192
  ds_read_b64_tr_b16 v[38:39], v209 offset:9216
  v_mfma_f32_32x32x16_bf16 v[96:111], v[52:55], v[56:59], v[96:111]
  ds_read_b128 v[40:43], v202 offset:0
  ds_read_b128 v[44:47], v202 offset:4096
  s_add_u32 m0, s82, 114688
  s_nop 0
  buffer_load_dwordx4 v196, s[56:59], s81 offen offset:0 lds
  s_add_u32 s83, s83, 3968
  v_mfma_f32_32x32x16_bf16 v[112:127], v[52:55], v[60:63], v[112:127]
  buffer_load_dwordx4 v197, s[56:59], s81 offen offset:1024 lds
  buffer_store_dwordx4 v[16:19], v25, s[60:63], s83 offen sc1
  s_waitcnt lgkmcnt(1)
  v_mfma_f32_32x32x16_bf16 v[64:79], v[32:35], v[40:43], v[64:79]
  ds_read_b64_tr_b16 v[48:49], v208 offset:12288
  ds_read_b64_tr_b16 v[50:51], v208 offset:13312
  buffer_store_dwordx4 v[20:23], v26, s[60:63], s83 offen sc1
  s_waitcnt lgkmcnt(2)
  v_mfma_f32_32x32x16_bf16 v[80:95], v[32:35], v[44:47], v[80:95]
  ds_read_b64_tr_b16 v[52:53], v209 offset:12288
  ds_read_b64_tr_b16 v[54:55], v209 offset:13312
  buffer_load_dwordx4 v198, s[56:59], s81 offen offset:2048 lds
  v_mov_b32 v253, 0
  v_mfma_f32_32x32x16_bf16 v[96:111], v[36:39], v[40:43], v[96:111]
  ds_read_b128 v[56:59], v203 offset:0
  ds_read_b128 v[60:63], v203 offset:4096
  buffer_load_dwordx4 v199, s[56:59], s81 offen offset:3072 lds
  s_add_u32 s80, s80, 128
  s_add_u32 s81, s81, 229376
  buffer_load_dwordx2 v[250:251], v253, s[92:95], 0 offen sc1
  v_mfma_f32_32x32x16_bf16 v[112:127], v[36:39], v[44:47], v[112:127]
  s_waitcnt vmcnt(19)
  s_barrier
  s_waitcnt lgkmcnt(1)
  v_mfma_f32_32x32x16_bf16 v[64:79], v[48:51], v[56:59], v[64:79]
  ds_read_b64_tr_b16 v[32:33], v208 offset:32768
  ds_read_b64_tr_b16 v[34:35], v208 offset:33792
  s_add_u32 m0, s82, 0
  s_nop 0
  buffer_load_dwordx4 v192, s[52:55], s80 offen offset:0 lds
  s_waitcnt lgkmcnt(2)
  v_mfma_f32_32x32x16_bf16 v[80:95], v[48:51], v[60:63], v[80:95]
  ds_read_b64_tr_b16 v[36:37], v209 offset:32768
  ds_read_b64_tr_b16 v[38:39], v209 offset:33792
  v_mfma_f32_32x32x16_bf16 v[96:111], v[52:55], v[56:59], v[96:111]
  ds_read_b128 v[40:43], v200 offset:32768
  ds_read_b128 v[44:47], v200 offset:36864
  buffer_load_dwordx4 v193, s[52:55], s80 offen offset:1024 lds
  v_mfma_f32_32x32x16_bf16 v[112:127], v[52:55], v[60:63], v[112:127]
  s_waitcnt lgkmcnt(1)
  v_mfma_f32_32x32x16_bf16 v[64:79], v[32:35], v[40:43], v[64:79]
  ds_read_b64_tr_b16 v[48:49], v208 offset:36864
  ds_read_b64_tr_b16 v[50:51], v208 offset:37888
  buffer_load_dwordx4 v194, s[52:55], s80 offen offset:2048 lds
  s_waitcnt lgkmcnt(2)
  v_mfma_f32_32x32x16_bf16 v[80:95], v[32:35], v[44:47], v[80:95]
  ds_read_b64_tr_b16 v[52:53], v209 offset:36864
  ds_read_b64_tr_b16 v[54:55], v209 offset:37888
  v_mfma_f32_32x32x16_bf16 v[96:111], v[36:39], v[40:43], v[96:111]
  ds_read_b128 v[56:59], v201 offset:32768
  ds_read_b128 v[60:63], v201 offset:36864
  buffer_load_dwordx4 v195, s[52:55], s80 offen offset:3072 lds
  v_mfma_f32_32x32x16_bf16 v[112:127], v[36:39], v[44:47], v[112:127]
  s_waitcnt lgkmcnt(1)
  v_mfma_f32_32x32x16_bf16 v[64:79], v[48:51], v[56:59], v[64:79]
  ds_read_b64_tr_b16 v[32:33], v208 offset:40960
  ds_read_b64_tr_b16 v[34:35], v208 offset:41984
  s_add_u32 m0, s82, 16384
  s_nop 0
  buffer_load_dwordx4 v196, s[56:59], s81 offen offset:0 lds
  s_waitcnt lgkmcnt(2)
  v_mfma_f32_32x32x16_bf16 v[80:95], v[48:51], v[60:63], v[80:95]
  ds_read_b64_tr_b16 v[36:37], v209 offset:40960
  ds_read_b64_tr_b16 v[38:39], v209 offset:41984
  v_mfma_f32_32x32x16_bf16 v[96:111], v[52:55], v[56:59], v[96:111]
  ds_read_b128 v[40:43], v202 offset:32768
  ds_read_b128 v[44:47], v202 offset:36864
  buffer_load_dwordx4 v197, s[56:59], s81 offen offset:1024 lds
  v_mfma_f32_32x32x16_bf16 v[112:127], v[52:55], v[60:63], v[112:127]
  s_waitcnt lgkmcnt(1)
  v_mfma_f32_32x32x16_bf16 v[64:79], v[32:35], v[40:43], v[64:79]
  ds_read_b64_tr_b16 v[48:49], v208 offset:45056
  ds_read_b64_tr_b16 v[50:51], v208 offset:46080
  buffer_load_dwordx4 v198, s[56:59], s81 offen offset:2048 lds
  s_waitcnt lgkmcnt(2)
  v_mfma_f32_32x32x16_bf16 v[80:95], v[32:35], v[44:47], v[80:95]
  ds_read_b64_tr_b16 v[52:53], v209 offset:45056
  ds_read_b64_tr_b16 v[54:55], v209 offset:46080
  v_mfma_f32_32x32x16_bf16 v[96:111], v[36:39], v[40:43], v[96:111]
  ds_read_b128 v[56:59], v203 offset:32768
  ds_read_b128 v[60:63], v203 offset:36864
  buffer_load_dwordx4 v199, s[56:59], s81 offen offset:3072 lds
  s_add_u32 s80, s80, 128
  s_add_u32 s81, s81, 229376
  v_mfma_f32_32x32x16_bf16 v[112:127], v[36:39], v[44:47], v[112:127]
  v_lshrrev_b32 v8, 2, v1
  v_and_b32 v9, 3, v1
  v_lshlrev_b32 v9, 7, v9
  v_lshl_add_u32 v9, v8, 10, v9
  s_lshl_b32 s83, s34, 2
  s_add_u32 s83, s83, s35
  s_mul_i32 s83, s83, 14336
  s_and_b32 s84, s33, 1
  s_lshl_b32 s84, s84, 9
  s_add_u32 s83, s83, s84
  s_mov_b32 exec_lo, 0xfffffff
  s_mov_b32 exec_hi, 0x0
  buffer_load_dword v186, v9, s[8:11], s83 offen
  s_mov_b64 exec, -1
  s_waitcnt vmcnt(20)
  s_barrier
  s_waitcnt lgkmcnt(1)
  s_nop 0
  v_mfma_f32_32x32x16_bf16 v[64:79], v[48:51], v[56:59], v[64:79]
  ds_read_b64_tr_b16 v[32:33], v210 offset:0
  ds_read_b64_tr_b16 v[34:35], v210 offset:1024
  s_add_u32 m0, s82, 32768
  s_nop 0
  buffer_load_dwordx4 v192, s[52:55], s80 offen offset:0 lds
  s_add_u32 s48, s30, 0x800000
  s_addc_u32 s49, s31, 0
  s_mov_b32 s50, 0x200000
  s_mov_b32 s51, 0x20000
  s_waitcnt lgkmcnt(2)
  v_mfma_f32_32x32x16_bf16 v[80:95], v[48:51], v[60:63], v[80:95]
  ds_read_b64_tr_b16 v[36:37], v211 offset:0
  ds_read_b64_tr_b16 v[38:39], v211 offset:1024
  s_mov_b32 s44, s12
  s_mov_b32 s45, s13
  s_mov_b32 s46, 0x200000
  s_mov_b32 s47, 0x20000
  v_mfma_f32_32x32x16_bf16 v[96:111], v[52:55], v[56:59], v[96:111]
  ds_read_b128 v[40:43], v204 offset:0
  ds_read_b128 v[44:47], v204 offset:4096
  buffer_load_dwordx4 v193, s[52:55], s80 offen offset:1024 lds
  s_mov_b32 s60, s14
  s_mov_b32 s61, s15
  s_mov_b32 s62, 0x400
  s_mov_b32 s63, 0x20000
  v_mfma_f32_32x32x16_bf16 v[112:127], v[52:55], v[60:63], v[112:127]
  s_waitcnt lgkmcnt(1)
  v_mfma_f32_32x32x16_bf16 v[64:79], v[32:35], v[40:43], v[64:79]
  ds_read_b64_tr_b16 v[48:49], v210 offset:4096
  ds_read_b64_tr_b16 v[50:51], v210 offset:5120
  buffer_load_dwordx4 v194, s[52:55], s80 offen offset:2048 lds
  s_lshr_b32 s36, s35, 1
  s_waitcnt lgkmcnt(2)
  v_mfma_f32_32x32x16_bf16 v[80:95], v[32:35], v[44:47], v[80:95]
  ds_read_b64_tr_b16 v[52:53], v211 offset:4096
  ds_read_b64_tr_b16 v[54:55], v211 offset:5120
  s_and_b32 s87, s35, 1
  v_mfma_f32_32x32x16_bf16 v[96:111], v[36:39], v[40:43], v[96:111]
  ds_read_b128 v[56:59], v205 offset:0
  ds_read_b128 v[60:63], v205 offset:4096
  buffer_load_dwordx4 v195, s[52:55], s80 offen offset:3072 lds
  v_mfma_f32_32x32x16_bf16 v[112:127], v[36:39], v[44:47], v[112:127]
  s_lshl_b32 s86, s33, 6
  s_waitcnt lgkmcnt(1)
  v_mfma_f32_32x32x16_bf16 v[64:79], v[48:51], v[56:59], v[64:79]
  ds_read_b64_tr_b16 v[32:33], v210 offset:8192
  ds_read_b64_tr_b16 v[34:35], v210 offset:9216
  s_add_u32 m0, s82, 49152
  s_nop 0
  buffer_load_dwordx4 v196, s[56:59], s81 offen offset:0 lds
  s_lshl_b32 s37, s34, 1
  s_waitcnt lgkmcnt(2)
  v_mfma_f32_32x32x16_bf16 v[80:95], v[48:51], v[60:63], v[80:95]
  ds_read_b64_tr_b16 v[36:37], v211 offset:8192
  ds_read_b64_tr_b16 v[38:39], v211 offset:9216
  v_mfma_f32_32x32x16_bf16 v[96:111], v[52:55], v[56:59], v[96:111]
  ds_read_b128 v[40:43], v206 offset:0
  ds_read_b128 v[44:47], v206 offset:4096
  buffer_load_dwordx4 v197, s[56:59], s81 offen offset:1024 lds
  s_add_u32 s86, s86, s37
  v_mfma_f32_32x32x16_bf16 v[112:127], v[52:55], v[60:63], v[112:127]
  s_add_u32 s86, s86, s36
  s_waitcnt lgkmcnt(1)
  v_mfma_f32_32x32x16_bf16 v[64:79], v[32:35], v[40:43], v[64:79]
  ds_read_b64_tr_b16 v[48:49], v210 offset:12288
  ds_read_b64_tr_b16 v[50:51], v210 offset:13312
  buffer_load_dwordx4 v198, s[56:59], s81 offen offset:2048 lds
  s_waitcnt lgkmcnt(2)
  v_mfma_f32_32x32x16_bf16 v[80:95], v[32:35], v[44:47], v[80:95]
  ds_read_b64_tr_b16 v[52:53], v211 offset:12288
  ds_read_b64_tr_b16 v[54:55], v211 offset:13312
  s_mul_i32 s88, s36, 21248
  v_mfma_f32_32x32x16_bf16 v[96:111], v[36:39], v[40:43], v[96:111]
  ds_read_b128 v[56:59], v207 offset:0
  ds_read_b128 v[60:63], v207 offset:4096
  buffer_load_dwordx4 v199, s[56:59], s81 offen offset:3072 lds
  s_add_u32 s80, s80, 128
  s_add_u32 s81, s81, 229376
  s_add_u32 s88, s88, 98560
  v_mfma_f32_32x32x16_bf16 v[112:127], v[36:39], v[44:47], v[112:127]
  v_lshrrev_b32 v8, 2, v1
  v_and_b32 v9, 3, v1
  v_lshlrev_b32 v9, 7, v9
  v_lshl_add_u32 v9, v8, 10, v9
  s_lshl_b32 s83, s34, 2
  s_add_u32 s83, s83, s35
  s_mul_i32 s83, s83, 14336
  s_and_b32 s84, s33, 1
  s_lshl_b32 s84, s84, 9
  s_add_u32 s83, s83, s84
  s_add_u32 s83, s83, 7168
  s_mov_b32 exec_lo, 0xfffffff
  s_mov_b32 exec_hi, 0x0
  buffer_load_dword v187, v9, s[8:11], s83 offen
  s_mov_b64 exec, -1
  s_waitcnt vmcnt(19)
  s_waitcnt vmcnt(18)
  s_barrier
  v_readfirstlane_b32 s36, v251
  v_readfirstlane_b32 s32, v250
  s_nop 0
  s_cmp_eq_u32 s36, 0
  s_cbranch_scc0 Ln2_ok
  s_mov_b32 s79, 0
Ln2_loop:
  s_sleep 2
  buffer_load_dwordx2 v[250:251], v253, s[92:95], 0 offen sc1
  s_waitcnt vmcnt(0)
  v_readfirstlane_b32 s36, v251
  v_readfirstlane_b32 s32, v250
  s_add_u32 s79, s79, 1
  s_cmp_lg_u32 s36, 0
  s_cbranch_scc1 Ln2_ok
  s_cmp_lt_u32 s79, 0x40000
  s_cbranch_scc1 Ln2_loop
Ln2_ok:
  s_cmp_eq_u32 s35, 0
  s_cbranch_scc0 g1_nofk
  s_lshl_b32 s36, s33, 5
  s_add_u32 s36, s36, s34
  s_lshl_b32 s36, s36, 7
  v_mov_b32 v252, s32
  v_mov_b32 v253, 0
  s_mov_b64 exec, 1
  buffer_store_dword v252, v253, s[96:99], s36 offen sc1
  s_mov_b64 exec, -1
g1_nofk:
  s_waitcnt lgkmcnt(1)
  s_nop 2
  v_mfma_f32_32x32x16_bf16 v[64:79], v[48:51], v[56:59], v[64:79]
  ds_read_b64_tr_b16 v[32:33], v210 offset:32768
  ds_read_b64_tr_b16 v[34:35], v210 offset:33792
  s_add_u32 m0, s82, 65536
  s_nop 0
  buffer_load_dwordx4 v192, s[52:55], s80 offen offset:0 lds
  s_waitcnt lgkmcnt(2)
  v_mfma_f32_32x32x16_bf16 v[80:95], v[48:51], v[60:63], v[80:95]
  ds_read_b64_tr_b16 v[36:37], v211 offset:32768
  ds_read_b64_tr_b16 v[38:39], v211 offset:33792
  v_mfma_f32_32x32x16_bf16 v[96:111], v[52:55], v[56:59], v[96:111]
  ds_read_b128 v[40:43], v204 offset:32768
  ds_read_b128 v[44:47], v204 offset:36864
  buffer_load_dwordx4 v193, s[52:55], s80 offen offset:1024 lds
  v_mfma_f32_32x32x16_bf16 v[112:127], v[52:55], v[60:63], v[112:127]
  s_waitcnt lgkmcnt(1)
  v_mfma_f32_32x32x16_bf16 v[64:79], v[32:35], v[40:43], v[64:79]
  ds_read_b64_tr_b16 v[48:49], v210 offset:36864
  ds_read_b64_tr_b16 v[50:51], v210 offset:37888
  buffer_load_dwordx4 v194, s[52:55], s80 offen offset:2048 lds
  s_waitcnt lgkmcnt(2)
  v_mfma_f32_32x32x16_bf16 v[80:95], v[32:35], v[44:47], v[80:95]
  ds_read_b64_tr_b16 v[52:53], v211 offset:36864
  ds_read_b64_tr_b16 v[54:55], v211 offset:37888
  v_mfma_f32_32x32x16_bf16 v[96:111], v[36:39], v[40:43], v[96:111]
  ds_read_b128 v[56:59], v205 offset:32768
  ds_read_b128 v[60:63], v205 offset:36864
  buffer_load_dwordx4 v195, s[52:55], s80 offen offset:3072 lds
  v_mfma_f32_32x32x16_bf16 v[112:127], v[36:39], v[44:47], v[112:127]
  s_waitcnt lgkmcnt(1)
  v_mfma_f32_32x32x16_bf16 v[64:79], v[48:51], v[56:59], v[64:79]
  ds_read_b64_tr_b16 v[32:33], v210 offset:40960
  ds_read_b64_tr_b16 v[34:35], v210 offset:41984
  s_add_u32 m0, s82, 81920
  s_nop 0
  buffer_load_dwordx4 v196, s[56:59], s81 offen offset:0 lds
  s_waitcnt lgkmcnt(2)
  v_mfma_f32_32x32x16_bf16 v[80:95], v[48:51], v[60:63], v[80:95]
  ds_read_b64_tr_b16 v[36:37], v211 offset:40960
  ds_read_b64_tr_b16 v[38:39], v211 offset:41984
  v_mfma_f32_32x32x16_bf16 v[96:111], v[52:55], v[56:59], v[96:111]
  ds_read_b128 v[40:43], v206 offset:32768
  ds_read_b128 v[44:47], v206 offset:36864
  buffer_load_dwordx4 v197, s[56:59], s81 offen offset:1024 lds
  v_mfma_f32_32x32x16_bf16 v[112:127], v[52:55], v[60:63], v[112:127]
  s_waitcnt lgkmcnt(1)
  v_mfma_f32_32x32x16_bf16 v[64:79], v[32:35], v[40:43], v[64:79]
  ds_read_b64_tr_b16 v[48:49], v210 offset:45056
  ds_read_b64_tr_b16 v[50:51], v210 offset:46080
  buffer_load_dwordx4 v198, s[56:59], s81 offen offset:2048 lds
  s_waitcnt lgkmcnt(2)
  v_mfma_f32_32x32x16_bf16 v[80:95], v[32:35], v[44:47], v[80:95]
  ds_read_b64_tr_b16 v[52:53], v211 offset:45056
  ds_read_b64_tr_b16 v[54:55], v211 offset:46080
  v_mfma_f32_32x32x16_bf16 v[96:111], v[36:39], v[40:43], v[96:111]
  ds_read_b128 v[56:59], v207 offset:32768
  ds_read_b128 v[60:63], v207 offset:36864
  buffer_load_dwordx4 v199, s[56:59], s81 offen offset:3072 lds
  s_add_u32 s80, s80, 128
  s_add_u32 s81, s81, 229376
  v_mfma_f32_32x32x16_bf16 v[112:127], v[36:39], v[44:47], v[112:127]
  v_lshlrev_b32 v9, 7, v1
  s_lshl_b32 s83, s33, 6
  s_lshl_b32 s84, s34, 1
  s_add_u32 s83, s83, s84
  s_lshl_b32 s83, s83, 12
  s_lshl_b32 s84, s35, 11
  s_add_u32 s83, s83, s84
  s_mov_b64 exec, 0xffff
  buffer_load_dword v191, v9, s[44:47], s83 offen
  s_mov_b64 exec, -1
  s_waitcnt vmcnt(19)
  s_barrier
  s_waitcnt lgkmcnt(1)
  s_nop 0
  v_mfma_f32_32x32x16_bf16 v[64:79], v[48:51], v[56:59], v[64:79]
  ds_read_b64_tr_b16 v[32:33], v208 offset:0
  ds_read_b64_tr_b16 v[34:35], v208 offset:1024
  s_add_u32 m0, s82, 98304
  s_nop 0
  buffer_load_dwordx4 v192, s[52:55], s80 offen offset:0 lds
  s_waitcnt lgkmcnt(2)
  v_mfma_f32_32x32x16_bf16 v[80:95], v[48:51], v[60:63], v[80:95]
  ds_read_b64_tr_b16 v[36:37], v209 offset:0
  ds_read_b64_tr_b16 v[38:39], v209 offset:1024
  v_mfma_f32_32x32x16_bf16 v[96:111], v[52:55], v[56:59], v[96:111]
  ds_read_b128 v[40:43], v200 offset:0
  ds_read_b128 v[44:47], v200 offset:4096
  buffer_load_dwordx4 v193, s[52:55], s80 offen offset:1024 lds
  v_mfma_f32_32x32x16_bf16 v[112:127], v[52:55], v[60:63], v[112:127]
  s_waitcnt lgkmcnt(1)
  v_mfma_f32_32x32x16_bf16 v[64:79], v[32:35], v[40:43], v[64:79]
  ds_read_b64_tr_b16 v[48:49], v208 offset:4096
  ds_read_b64_tr_b16 v[50:51], v208 offset:5120
  buffer_load_dwordx4 v194, s[52:55], s80 offen offset:2048 lds
  s_waitcnt lgkmcnt(2)
  v_mfma_f32_32x32x16_bf16 v[80:95], v[32:35], v[44:47], v[80:95]
  ds_read_b64_tr_b16 v[52:53], v209 offset:4096
  ds_read_b64_tr_b16 v[54:55], v209 offset:5120
  v_mfma_f32_32x32x16_bf16 v[96:111], v[36:39], v[40:43], v[96:111]
  ds_read_b128 v[56:59], v201 offset:0
  ds_read_b128 v[60:63], v201 offset:4096
  buffer_load_dwordx4 v195, s[52:55], s80 offen offset:3072 lds
  v_mfma_f32_32x32x16_bf16 v[112:127], v[36:39], v[44:47], v[112:127]
  s_waitcnt lgkmcnt(1)
  v_mfma_f32_32x32x16_bf16 v[64:79], v[48:51], v[56:59], v[64:79]
  ds_read_b64_tr_b16 v[32:33], v208 offset:8192
  ds_read_b64_tr_b16 v[34:35], v208 offset:9216
  s_add_u32 m0, s82, 114688
  s_nop 0
  buffer_load_dwordx4 v196, s[56:59], s81 offen offset:0 lds
  s_waitcnt lgkmcnt(2)
  v_mfma_f32_32x32x16_bf16 v[80:95], v[48:51], v[60:63], v[80:95]
  ds_read_b64_tr_b16 v[36:37], v209 offset:8192
  ds_read_b64_tr_b16 v[38:39], v209 offset:9216
  v_mfma_f32_32x32x16_bf16 v[96:111], v[52:55], v[56:59], v[96:111]
  ds_read_b128 v[40:43], v202 offset:0
  ds_read_b128 v[44:47], v202 offset:4096
  buffer_load_dwordx4 v197, s[56:59], s81 offen offset:1024 lds
  v_mfma_f32_32x32x16_bf16 v[112:127], v[52:55], v[60:63], v[112:127]
  s_waitcnt lgkmcnt(1)
  v_mfma_f32_32x32x16_bf16 v[64:79], v[32:35], v[40:43], v[64:79]
  ds_read_b64_tr_b16 v[48:49], v208 offset:12288
  ds_read_b64_tr_b16 v[50:51], v208 offset:13312
  buffer_load_dwordx4 v198, s[56:59], s81 offen offset:2048 lds
  s_waitcnt lgkmcnt(2)
  v_mfma_f32_32x32x16_bf16 v[80:95], v[32:35], v[44:47], v[80:95]
  ds_read_b64_tr_b16 v[52:53], v209 offset:12288
  ds_read_b64_tr_b16 v[54:55], v209 offset:13312
  v_mfma_f32_32x32x16_bf16 v[96:111], v[36:39], v[40:43], v[96:111]
  ds_read_b128 v[56:59], v203 offset:0
  ds_read_b128 v[60:63], v203 offset:4096
  buffer_load_dwordx4 v199, s[56:59], s81 offen offset:3072 lds
  s_add_u32 s80, s80, 128
  s_add_u32 s81, s81, 229376
  v_mfma_f32_32x32x16_bf16 v[112:127], v[36:39], v[44:47], v[112:127]
  s_waitcnt vmcnt(18)
  s_barrier
  s_waitcnt lgkmcnt(1)
  v_mfma_f32_32x32x16_bf16 v[64:79], v[48:51], v[56:59], v[64:79]
  ds_read_b64_tr_b16 v[32:33], v208 offset:32768
  ds_read_b64_tr_b16 v[34:35], v208 offset:33792
  v_lshlrev_b32 v10, 4, v1
  s_lshl_b32 s83, s35, 2
  s_waitcnt lgkmcnt(2)
  v_mfma_f32_32x32x16_bf16 v[80:95], v[48:51], v[60:63], v[80:95]
  ds_read_b64_tr_b16 v[36:37], v209 offset:32768
  ds_read_b64_tr_b16 v[38:39], v209 offset:33792
  s_mul_i32 s83, s83, 14336
  s_lshl_b32 s84, s74, 10
  v_mfma_f32_32x32x16_bf16 v[96:111], v[52:55], v[56:59], v[96:111]
  ds_read_b128 v[40:43], v200 offset:32768
  ds_read_b128 v[44:47], v200 offset:36864
  s_add_u32 s83, s83, s84
  buffer_load_dwordx4 v[128:131], v10, s[68:71], s83 offen sc1
  v_mfma_f32_32x32x16_bf16 v[112:127], v[52:55], v[60:63], v[112:127]
  s_add_u32 s83, s83, 14336
  buffer_load_dwordx4 v[132:135], v10, s[68:71], s83 offen sc1
  s_waitcnt lgkmcnt(1)
  v_mfma_f32_32x32x16_bf16 v[64:79], v[32:35], v[40:43], v[64:79]
  ds_read_b64_tr_b16 v[48:49], v208 offset:36864
  ds_read_b64_tr_b16 v[50:51], v208 offset:37888
  s_add_u32 s83, s83, 14336
  buffer_load_dwordx4 v[136:139], v10, s[68:71], s83 offen sc1
  s_waitcnt lgkmcnt(2)
  v_mfma_f32_32x32x16_bf16 v[80:95], v[32:35], v[44:47], v[80:95]
  ds_read_b64_tr_b16 v[52:53], v209 offset:36864
  ds_read_b64_tr_b16 v[54:55], v209 offset:37888
  s_add_u32 s83, s83, 14336
  v_mfma_f32_32x32x16_bf16 v[96:111], v[36:39], v[40:43], v[96:111]
  ds_read_b128 v[56:59], v201 offset:32768
  ds_read_b128 v[60:63], v201 offset:36864
  buffer_load_dwordx4 v[140:143], v10, s[68:71], s83 offen sc1
  s_lshr_b32 s84, s35, 1
  v_mfma_f32_32x32x16_bf16 v[112:127], v[36:39], v[44:47], v[112:127]
  s_lshl_b32 s84, s84, 6
  s_lshl_b32 s83, s73, 7
  s_waitcnt lgkmcnt(1)
  v_mfma_f32_32x32x16_bf16 v[64:79], v[48:51], v[56:59], v[64:79]
  ds_read_b64_tr_b16 v[32:33], v208 offset:40960
  ds_read_b64_tr_b16 v[34:35], v208 offset:41984
  s_add_u32 s83, s83, s84
  s_lshl_b32 s83, s83, 4
  s_waitcnt lgkmcnt(2)
  v_mfma_f32_32x32x16_bf16 v[80:95], v[48:51], v[60:63], v[80:95]
  ds_read_b64_tr_b16 v[36:37], v209 offset:40960
  ds_read_b64_tr_b16 v[38:39], v209 offset:41984
  v_and_b32 v12, 31, v1
  v_lshlrev_b32 v12, 4, v12
  v_mfma_f32_32x32x16_bf16 v[96:111], v[52:55], v[56:59], v[96:111]
  ds_read_b128 v[40:43], v202 offset:32768
  ds_read_b128 v[44:47], v202 offset:36864
  buffer_load_dwordx4 v[212:215], v12, s[64:67], s83 offen sc1
  v_mfma_f32_32x32x16_bf16 v[112:127], v[52:55], v[60:63], v[112:127]
  buffer_load_dwordx4 v[216:219], v12, s[64:67], s83 offen offset:512 sc1
  v_and_b32 v14, 127, v0
  s_waitcnt lgkmcnt(1)
  v_mfma_f32_32x32x16_bf16 v[64:79], v[32:35], v[40:43], v[64:79]
  ds_read_b64_tr_b16 v[48:49], v208 offset:45056
  ds_read_b64_tr_b16 v[50:51], v208 offset:46080
  v_lshlrev_b32 v14, 1, v14
  s_lshl_b32 s84, s74, 8
  s_waitcnt lgkmcnt(2)
  v_mfma_f32_32x32x16_bf16 v[80:95], v[32:35], v[44:47], v[80:95]
  ds_read_b64_tr_b16 v[52:53], v209 offset:45056
  ds_read_b64_tr_b16 v[54:55], v209 offset:46080
  buffer_load_ushort v180, v14, s[40:43], s84 offen
  s_add_u32 m0, s17, 0
  s_add_u32 s75, s3, 196608
  buffer_load_dwordx4 v246, s[8:11], s75 offen lds
  buffer_load_dwordx4 v247, s[8:11], s75 offen offset:1024 lds
  v_mfma_f32_32x32x16_bf16 v[96:111], v[36:39], v[40:43], v[96:111]
  ds_read_b128 v[56:59], v203 offset:32768
  ds_read_b128 v[60:63], v203 offset:36864
  s_add_u32 m0, s17, 8192
  s_add_u32 s75, s3, 212992
  buffer_load_dwordx4 v246, s[8:11], s75 offen lds
  buffer_load_dwordx4 v247, s[8:11], s75 offen offset:1024 lds
  s_add_u32 m0, s17, 16384
  s_add_u32 s75, s3, 229376
  buffer_load_dwordx4 v246, s[8:11], s75 offen lds
  buffer_load_dwordx4 v247, s[8:11], s75 offen offset:1024 lds
  v_mfma_f32_32x32x16_bf16 v[112:127], v[36:39], v[44:47], v[112:127]
  s_add_u32 m0, s17, 24576
  s_add_u32 s75, s3, 245760
  buffer_load_dwordx4 v246, s[8:11], s75 offen lds
  buffer_load_dwordx4 v247, s[8:11], s75 offen offset:1024 lds
  s_waitcnt vmcnt(24)
  s_barrier
  s_waitcnt lgkmcnt(1)
  v_mfma_f32_32x32x16_bf16 v[64:79], v[48:51], v[56:59], v[64:79]
  ds_read_b64_tr_b16 v[32:33], v210 offset:0
  ds_read_b64_tr_b16 v[34:35], v210 offset:1024
  v_min_u32 v185, 31, v1
  s_waitcnt lgkmcnt(2)
  v_mfma_f32_32x32x16_bf16 v[80:95], v[48:51], v[60:63], v[80:95]
  ds_read_b64_tr_b16 v[36:37], v211 offset:0
  ds_read_b64_tr_b16 v[38:39], v211 offset:1024
  v_lshlrev_b32 v185, 7, v185
  v_mfma_f32_32x32x16_bf16 v[96:111], v[52:55], v[56:59], v[96:111]
  ds_read_b128 v[40:43], v204 offset:0
  ds_read_b128 v[44:47], v204 offset:4096
  v_mfma_f32_32x32x16_bf16 v[112:127], v[52:55], v[60:63], v[112:127]
  s_lshl_b32 s85, s33, 12
  s_waitcnt lgkmcnt(1)
  v_mfma_f32_32x32x16_bf16 v[64:79], v[32:35], v[40:43], v[64:79]
  ds_read_b64_tr_b16 v[48:49], v210 offset:4096
  ds_read_b64_tr_b16 v[50:51], v210 offset:5120
  s_waitcnt lgkmcnt(2)
  v_mfma_f32_32x32x16_bf16 v[80:95], v[32:35], v[44:47], v[80:95]
  ds_read_b64_tr_b16 v[52:53], v211 offset:4096
  ds_read_b64_tr_b16 v[54:55], v211 offset:5120
  buffer_load_dword v184, v185, s[96:99], s85 offen sc1
  v_mfma_f32_32x32x16_bf16 v[96:111], v[36:39], v[40:43], v[96:111]
  ds_read_b128 v[56:59], v205 offset:0
  ds_read_b128 v[60:63], v205 offset:4096
  v_mfma_f32_32x32x16_bf16 v[112:127], v[36:39], v[44:47], v[112:127]
  s_add_u32 m0, s17, 32768
  s_add_u32 s75, s3, 262144
  buffer_load_dwordx4 v246, s[8:11], s75 offen lds
  buffer_load_dwordx4 v247, s[8:11], s75 offen offset:1024 lds
  s_waitcnt lgkmcnt(1)
  v_mfma_f32_32x32x16_bf16 v[64:79], v[48:51], v[56:59], v[64:79]
  ds_read_b64_tr_b16 v[32:33], v210 offset:8192
  ds_read_b64_tr_b16 v[34:35], v210 offset:9216
  s_add_u32 m0, s17, 40960
  s_add_u32 s75, s3, 278528
  buffer_load_dwordx4 v246, s[8:11], s75 offen lds
  buffer_load_dwordx4 v247, s[8:11], s75 offen offset:1024 lds
  s_waitcnt lgkmcnt(2)
  v_mfma_f32_32x32x16_bf16 v[80:95], v[48:51], v[60:63], v[80:95]
  ds_read_b64_tr_b16 v[36:37], v211 offset:8192
  ds_read_b64_tr_b16 v[38:39], v211 offset:9216
  v_mfma_f32_32x32x16_bf16 v[96:111], v[52:55], v[56:59], v[96:111]
  ds_read_b128 v[40:43], v206 offset:0
  ds_read_b128 v[44:47], v206 offset:4096
  s_waitcnt vmcnt(13)
  v_min3_u32 v10, v129, v133, v137
  v_max3_u32 v11, v129, v133, v137
  v_min3_u32 v10, v10, v141, v131
  v_max3_u32 v11, v11, v141, v131
  v_min3_u32 v10, v10, v135, v139
  v_max3_u32 v11, v11, v135, v139
  v_min3_u32 v10, v10, v143, v213
  v_max3_u32 v11, v11, v143, v213
  v_min3_u32 v10, v10, v215, v217
  v_max3_u32 v11, v11, v215, v217
  v_min_u32 v10, v10, v219
  v_max_u32 v11, v11, v219
  v_cmp_ne_u32 vcc, s32, v10
  v_cmp_ne_u32 s[76:77], s32, v11
  s_nop 1
  s_or_b64 vcc, vcc, s[76:77]
  s_nop 4
  s_cbranch_vccz Lt3_ok
  s_mov_b32 s79, 0
Lt3_loop:
  s_sleep 2
  v_lshlrev_b32 v10, 4, v1
  s_lshl_b32 s83, s35, 2
  s_mul_i32 s83, s83, 14336
  s_lshl_b32 s84, s74, 10
  s_add_u32 s83, s83, s84
  buffer_load_dwordx4 v[128:131], v10, s[68:71], s83 offen sc1
  s_add_u32 s83, s83, 14336
  buffer_load_dwordx4 v[132:135], v10, s[68:71], s83 offen sc1
  s_add_u32 s83, s83, 14336
  buffer_load_dwordx4 v[136:139], v10, s[68:71], s83 offen sc1
  s_add_u32 s83, s83, 14336
  buffer_load_dwordx4 v[140:143], v10, s[68:71], s83 offen sc1
  s_lshr_b32 s84, s35, 1
  s_lshl_b32 s84, s84, 6
  s_lshl_b32 s83, s73, 7
  s_add_u32 s83, s83, s84
  s_lshl_b32 s83, s83, 4
  v_and_b32 v12, 31, v1
  v_lshlrev_b32 v12, 4, v12
  buffer_load_dwordx4 v[212:215], v12, s[64:67], s83 offen sc1
  buffer_load_dwordx4 v[216:219], v12, s[64:67], s83 offen offset:512 sc1
  s_waitcnt vmcnt(0)
  v_min3_u32 v10, v129, v133, v137
  v_max3_u32 v11, v129, v133, v137
  v_min3_u32 v10, v10, v141, v131
  v_max3_u32 v11, v11, v141, v131
  v_min3_u32 v10, v10, v135, v139
  v_max3_u32 v11, v11, v135, v139
  v_min3_u32 v10, v10, v143, v213
  v_max3_u32 v11, v11, v143, v213
  v_min3_u32 v10, v10, v215, v217
  v_max3_u32 v11, v11, v215, v217
  v_min_u32 v10, v10, v219
  v_max_u32 v11, v11, v219
  v_cmp_ne_u32 vcc, s32, v10
  v_cmp_ne_u32 s[76:77], s32, v11
  s_nop 1
  s_or_b64 vcc, vcc, s[76:77]
  s_nop 4
  s_cbranch_vccz Lt3_ok
  s_add_u32 s79, s79, 1
  s_cmp_lt_u32 s79, 0x40000
  s_cbranch_scc1 Lt3_loop
Lt3_ok:
  v_mov_b32 v213, v214
  v_mov_b32 v217, v218
  v_add_f32 v128, v128, v132
  v_add_f32 v130, v130, v134
  v_add_f32 v136, v136, v140
  v_add_f32 v138, v138, v142
  v_add_f32 v128, v128, v136
  v_add_f32 v129, v130, v138
  v_lshlrev_b32 v10, 3, v1
  s_lshl_b32 s83, s35, 9
  v_add_u32 v10, s83, v10
  v_add_u32 v10, 158464, v10
  ds_write_b64 v10, v[128:129]
  v_mfma_f32_32x32x16_bf16 v[112:127], v[52:55], v[60:63], v[112:127]
  s_waitcnt lgkmcnt(2)
  v_mfma_f32_32x32x16_bf16 v[64:79], v[32:35], v[40:43], v[64:79]
  ds_read_b64_tr_b16 v[48:49], v210 offset:12288
  ds_read_b64_tr_b16 v[50:51], v210 offset:13312
  s_add_u32 m0, s17, 49152
  s_add_u32 s75, s3, 294912
  buffer_load_dwordx4 v246, s[8:11], s75 offen lds
  buffer_load_dwordx4 v247, s[8:11], s75 offen offset:1024 lds
  s_waitcnt lgkmcnt(3)
  v_mfma_f32_32x32x16_bf16 v[80:95], v[32:35], v[44:47], v[80:95]
  ds_read_b64_tr_b16 v[52:53], v211 offset:12288
  ds_read_b64_tr_b16 v[54:55], v211 offset:13312
  v_mfma_f32_32x32x16_bf16 v[96:111], v[36:39], v[40:43], v[96:111]
  ds_read_b128 v[56:59], v207 offset:0
  ds_read_b128 v[60:63], v207 offset:4096
  s_add_u32 m0, s17, 57344
  s_add_u32 s75, s3, 311296
  buffer_load_dwordx4 v246, s[8:11], s75 offen lds
  buffer_load_dwordx4 v247, s[8:11], s75 offen offset:1024 lds
  v_mfma_f32_32x32x16_bf16 v[112:127], v[36:39], v[44:47], v[112:127]
  s_waitcnt lgkmcnt(0)
  s_barrier
  v_mfma_f32_32x32x16_bf16 v[64:79], v[48:51], v[56:59], v[64:79]
  ds_read_b64_tr_b16 v[32:33], v210 offset:32768
  ds_read_b64_tr_b16 v[34:35], v210 offset:33792
  v_and_b32 v10, 127, v0
  v_lshlrev_b32 v10, 2, v10
  v_mfma_f32_32x32x16_bf16 v[80:95], v[48:51], v[60:63], v[80:95]
  ds_read_b64_tr_b16 v[36:37], v211 offset:32768
  ds_read_b64_tr_b16 v[38:39], v211 offset:33792
  v_add_u32 v11, 158464, v10
  v_add_u32 v10, 157440, v10
  v_mfma_f32_32x32x16_bf16 v[96:111], v[52:55], v[56:59], v[96:111]
  ds_read_b128 v[40:43], v204 offset:32768
  ds_read_b128 v[44:47], v204 offset:36864
  ds_read_b32 v20, v11 offset:0
  ds_read_b32 v21, v11 offset:512
  v_mfma_f32_32x32x16_bf16 v[112:127], v[52:55], v[60:63], v[112:127]
  ds_read_b32 v22, v11 offset:1024
  ds_read_b32 v23, v11 offset:1536
  s_waitcnt lgkmcnt(5)
  v_mfma_f32_32x32x16_bf16 v[64:79], v[32:35], v[40:43], v[64:79]
  ds_read_b64_tr_b16 v[48:49], v210 offset:36864
  ds_read_b64_tr_b16 v[50:51], v210 offset:37888
  v_lshlrev_b32 v180, 16, v180
  s_waitcnt lgkmcnt(4)
  v_add_f32 v20, v20, v21
  v_mfma_f32_32x32x16_bf16 v[80:95], v[32:35], v[44:47], v[80:95]
  ds_read_b64_tr_b16 v[52:53], v211 offset:36864
  ds_read_b64_tr_b16 v[54:55], v211 offset:37888
  s_waitcnt lgkmcnt(4)
  v_add_f32 v22, v22, v23
  v_add_f32 v20, v20, v22
  v_mfma_f32_32x32x16_bf16 v[96:111], v[36:39], v[40:43], v[96:111]
  ds_read_b128 v[56:59], v205 offset:32768
  ds_read_b128 v[60:63], v205 offset:36864
  ds_write_b32 v10, v20
  ds_write_b32 v10, v180 offset:512
  v_mfma_f32_32x32x16_bf16 v[112:127], v[36:39], v[44:47], v[112:127]
  s_add_u32 m0, s17, 65536
  s_add_u32 s75, s3, 327680
  buffer_load_dwordx4 v246, s[8:11], s75 offen lds
  buffer_load_dwordx4 v247, s[8:11], s75 offen offset:1024 lds
  s_add_u32 m0, s17, 73728
  s_add_u32 s75, s3, 344064
  buffer_load_dwordx4 v246, s[8:11], s75 offen lds
  buffer_load_dwordx4 v247, s[8:11], s75 offen offset:1024 lds
  s_waitcnt lgkmcnt(3)
  v_mfma_f32_32x32x16_bf16 v[64:79], v[48:51], v[56:59], v[64:79]
  ds_read_b64_tr_b16 v[32:33], v210 offset:40960
  ds_read_b64_tr_b16 v[34:35], v210 offset:41984
  s_waitcnt vmcnt(12)
  v_cmp_ne_u32 vcc, s32, v184
  s_nop 4
  s_cbranch_vccz Lp4_ok
  s_mov_b32 s79, 0
Lp4_loop:
  s_sleep 2
  buffer_load_dword v184, v185, s[96:99], s85 offen sc1
  s_waitcnt vmcnt(0)
  v_cmp_ne_u32 vcc, s32, v184
  s_nop 4
  s_cbranch_vccz Lp4_ok
  s_add_u32 s79, s79, 1
  s_cmp_lt_u32 s79, 0x40000
  s_cbranch_scc1 Lp4_loop
Lp4_ok:
  s_lshl_b32 s83, s86, 12
  s_waitcnt lgkmcnt(4)
  v_mfma_f32_32x32x16_bf16 v[80:95], v[48:51], v[60:63], v[80:95]
  ds_read_b64_tr_b16 v[36:37], v211 offset:40960
  ds_read_b64_tr_b16 v[38:39], v211 offset:41984
  s_lshl_b32 s84, s87, 11
  s_add_u32 s83, s83, s84
  v_mfma_f32_32x32x16_bf16 v[96:111], v[52:55], v[56:59], v[96:111]
  ds_read_b128 v[40:43], v206 offset:32768
  ds_read_b128 v[44:47], v206 offset:36864
  v_lshlrev_b32 v2, 4, v1
  buffer_load_dwordx4 v[220:223], v2, s[48:51], s83 offen offset:0 sc1
  v_mfma_f32_32x32x16_bf16 v[112:127], v[52:55], v[60:63], v[112:127]
  buffer_load_dwordx4 v[224:227], v2, s[48:51], s83 offen offset:4 sc1
  buffer_load_dwordx4 v[228:231], v2, s[48:51], s83 offen offset:8 sc1
  s_waitcnt lgkmcnt(1)
  v_mfma_f32_32x32x16_bf16 v[64:79], v[32:35], v[40:43], v[64:79]
  ds_read_b64_tr_b16 v[48:49], v210 offset:45056
  ds_read_b64_tr_b16 v[50:51], v210 offset:46080
  buffer_load_dwordx4 v[232:235], v2, s[48:51], s83 offen offset:1024 sc1
  buffer_load_dwordx4 v[236:239], v2, s[48:51], s83 offen offset:1028 sc1
  s_waitcnt lgkmcnt(2)
  v_mfma_f32_32x32x16_bf16 v[80:95], v[32:35], v[44:47], v[80:95]
  ds_read_b64_tr_b16 v[52:53], v211 offset:45056
  ds_read_b64_tr_b16 v[54:55], v211 offset:46080
  buffer_load_dwordx4 v[240:243], v2, s[48:51], s83 offen offset:1032 sc1
  v_mov_b32 v4, 0
  v_mfma_f32_32x32x16_bf16 v[96:111], v[36:39], v[40:43], v[96:111]
  ds_read_b128 v[56:59], v207 offset:32768
  ds_read_b128 v[60:63], v207 offset:36864
  s_lshl_b32 s84, s86, 1
  buffer_load_ushort v254, v4, s[60:63], s84 offen
  v_mfma_f32_32x32x16_bf16 v[112:127], v[36:39], v[44:47], v[112:127]
  s_add_u32 m0, s17, 81920
  s_add_u32 s75, s3, 360448
  buffer_load_dwordx4 v246, s[8:11], s75 offen lds
  buffer_load_dwordx4 v247, s[8:11], s75 offen offset:1024 lds
  s_add_u32 m0, s17, 90112
  s_add_u32 s75, s3, 376832
  buffer_load_dwordx4 v246, s[8:11], s75 offen lds
  buffer_load_dwordx4 v247, s[8:11], s75 offen offset:1024 lds
  s_waitcnt lgkmcnt(1)
  v_mfma_f32_32x32x16_bf16 v[64:79], v[48:51], v[56:59], v[64:79]
  s_waitcnt lgkmcnt(0)
  v_mfma_f32_32x32x16_bf16 v[80:95], v[48:51], v[60:63], v[80:95]
  v_mfma_f32_32x32x16_bf16 v[96:111], v[52:55], v[56:59], v[96:111]
  v_mfma_f32_32x32x16_bf16 v[112:127], v[52:55], v[60:63], v[112:127]
  s_waitcnt lgkmcnt(0)
  s_barrier
  s_lshl_b32 s36, s86, 12
  s_lshl_b32 s37, s87, 11
  s_add_u32 s36, s36, s37
  v_lshlrev_b32 v2, 4, v1
  s_add_u32 s38, s88, s37
  s_add_u32 m0, s38, 17152
  s_add_u32 s38, s36, 0
  buffer_load_dwordx4 v2, s[44:47], s38 offen lds
  s_add_u32 s38, s88, s37
  s_add_u32 m0, s38, 18176
  s_add_u32 s38, s36, 1024
  buffer_load_dwordx4 v2, s[44:47], s38 offen lds
  v_mov_b32 v16, 0
  v_mov_b32 v17, 0
  v_mov_b32 v18, 0
  v_mov_b32 v19, 0
  v_lshrrev_b32 v5, 1, v1
  v_mul_u32_u24 v5, 4160, v5
  v_and_b32 v6, 1, v1
  v_lshl_add_u32 v5, v6, 4, v5
  v_add_u32 v5, 4096, v5
  v_add_u32 v6, 16640, v2
  s_cmp_eq_u32 s87, 0
  s_cselect_b32 s76, 0xff, -1
  s_cselect_b64 vcc, -1, 0
  v_cndmask_b32 v5, v6, v5, vcc
  v_add_u32 v5, s88, v5
  s_mov_b32 exec_lo, s76
  s_mov_b32 exec_hi, 0
  ds_write_b128 v5, v[16:19]
  s_mov_b64 exec, -1
  s_mov_b32 s44, s30
  s_mov_b32 s45, s31
  s_mov_b32 s46, 0x700000
  s_mov_b32 s47, 0x20000
  v_lshrrev_b32 v10, 5, v1
  v_lshlrev_b32 v10, 4, v10
  s_and_b32 s37, s35, 1
  s_lshl_b32 s37, s37, 8
  v_add_u32 v10, s37, v10
  v_add_u32 v10, 157440, v10
  ds_read_b128 v[128:131], v10 offset:0
  ds_read_b128 v[144:147], v10 offset:512
  ds_read_b128 v[132:135], v10 offset:32
  ds_read_b128 v[148:151], v10 offset:544
  ds_read_b128 v[136:139], v10 offset:64
  ds_read_b128 v[152:155], v10 offset:576
  ds_read_b128 v[140:143], v10 offset:96
  ds_read_b128 v[156:159], v10 offset:608
  s_lshr_b32 s37, s35, 1
  s_lshl_b32 s37, s37, 1
  s_lshl_b32 s36, s73, 2
  s_add_u32 s36, s36, s37
  s_mul_i32 s36, s36, 112
  s_lshl_b32 s37, s74, 3
  s_add_u32 s36, s36, s37
  s_and_b32 s37, s35, 1
  s_lshl_b32 s37, s37, 2
  s_add_u32 s36, s36, s37
  s_lshl_b32 s83, s36, 10
  v_lshlrev_b32 v11, 4, v1
  v_add_u32 v12, 114688, v11
  v_mul_f32 v212, v212, v213
  v_mul_f32 v216, v216, v217
  ds_read_b128 v[32:35], v10 offset:128
  ds_read_b128 v[48:51], v10 offset:640
  ds_read_b128 v[36:39], v10 offset:160
  ds_read_b128 v[52:55], v10 offset:672
  ds_read_b128 v[40:43], v10 offset:192
  ds_read_b128 v[56:59], v10 offset:704
  ds_read_b128 v[44:47], v10 offset:224
  ds_read_b128 v[60:63], v10 offset:736
  s_waitcnt lgkmcnt(14)
  v_pk_fma_f32 v[176:177], v[212:213], v[128:129], v[144:145] op_sel_hi:[0,1,1] neg_lo:[1,0,0] neg_hi:[1,0,0]
  v_pk_fma_f32 v[178:179], v[212:213], v[130:131], v[146:147] op_sel_hi:[0,1,1] neg_lo:[1,0,0] neg_hi:[1,0,0]
  v_pk_fma_f32 v[176:177], v[64:65], v[212:213], v[176:177] op_sel:[0,1,0] op_sel_hi:[1,1,1]
  v_pk_fma_f32 v[178:179], v[66:67], v[212:213], v[178:179] op_sel:[0,1,0] op_sel_hi:[1,1,1]
  v_max_f32 v176, 0, v176
  v_max_f32 v177, 0, v177
  v_max_f32 v178, 0, v178
  v_max_f32 v179, 0, v179
  v_pk_mul_f32 v[176:177], v[176:177], v[176:177]
  v_pk_mul_f32 v[178:179], v[178:179], v[178:179]
  v_cvt_pk_bf16_f32 v160, v176, v177
  v_cvt_pk_bf16_f32 v161, v178, v179
  s_waitcnt lgkmcnt(12)
  v_pk_fma_f32 v[176:177], v[212:213], v[132:133], v[148:149] op_sel_hi:[0,1,1] neg_lo:[1,0,0] neg_hi:[1,0,0]
  v_pk_fma_f32 v[178:179], v[212:213], v[134:135], v[150:151] op_sel_hi:[0,1,1] neg_lo:[1,0,0] neg_hi:[1,0,0]
  v_pk_fma_f32 v[176:177], v[68:69], v[212:213], v[176:177] op_sel:[0,1,0] op_sel_hi:[1,1,1]
  v_pk_fma_f32 v[178:179], v[70:71], v[212:213], v[178:179] op_sel:[0,1,0] op_sel_hi:[1,1,1]
  v_max_f32 v176, 0, v176
  v_max_f32 v177, 0, v177
  v_max_f32 v178, 0, v178
  v_max_f32 v179, 0, v179
  v_pk_mul_f32 v[176:177], v[176:177], v[176:177]
  v_pk_mul_f32 v[178:179], v[178:179], v[178:179]
  v_cvt_pk_bf16_f32 v162, v176, v177
  v_cvt_pk_bf16_f32 v163, v178, v179
  s_waitcnt lgkmcnt(10)
  v_pk_fma_f32 v[176:177], v[212:213], v[136:137], v[152:153] op_sel_hi:[0,1,1] neg_lo:[1,0,0] neg_hi:[1,0,0]
  v_pk_fma_f32 v[178:179], v[212:213], v[138:139], v[154:155] op_sel_hi:[0,1,1] neg_lo:[1,0,0] neg_hi:[1,0,0]
  v_pk_fma_f32 v[176:177], v[72:73], v[212:213], v[176:177] op_sel:[0,1,0] op_sel_hi:[1,1,1]
  v_pk_fma_f32 v[178:179], v[74:75], v[212:213], v[178:179] op_sel:[0,1,0] op_sel_hi:[1,1,1]
  v_max_f32 v176, 0, v176
  v_max_f32 v177, 0, v177
  v_max_f32 v178, 0, v178
  v_max_f32 v179, 0, v179
  v_pk_mul_f32 v[176:177], v[176:177], v[176:177]
  v_pk_mul_f32 v[178:179], v[178:179], v[178:179]
  v_cvt_pk_bf16_f32 v164, v176, v177
  v_cvt_pk_bf16_f32 v165, v178, v179
  s_waitcnt lgkmcnt(8)
  v_pk_fma_f32 v[176:177], v[212:213], v[140:141], v[156:157] op_sel_hi:[0,1,1] neg_lo:[1,0,0] neg_hi:[1,0,0]
  v_pk_fma_f32 v[178:179], v[212:213], v[142:143], v[158:159] op_sel_hi:[0,1,1] neg_lo:[1,0,0] neg_hi:[1,0,0]
  v_pk_fma_f32 v[176:177], v[76:77], v[212:213], v[176:177] op_sel:[0,1,0] op_sel_hi:[1,1,1]
  v_pk_fma_f32 v[178:179], v[78:79], v[212:213], v[178:179] op_sel:[0,1,0] op_sel_hi:[1,1,1]
  v_max_f32 v176, 0, v176
  v_max_f32 v177, 0, v177
  v_max_f32 v178, 0, v178
  v_max_f32 v179, 0, v179
  v_pk_mul_f32 v[176:177], v[176:177], v[176:177]
  v_pk_mul_f32 v[178:179], v[178:179], v[178:179]
  v_cvt_pk_bf16_f32 v166, v176, v177
  v_cvt_pk_bf16_f32 v167, v178, v179
  buffer_store_dwordx4 v[160:163], v11, s[44:47], s83 offen offset:0 sc1
  buffer_store_dwordx4 v[164:167], v11, s[44:47], s83 offen offset:1024 sc1
  v_pk_fma_f32 v[176:177], v[216:217], v[128:129], v[144:145] op_sel_hi:[0,1,1] neg_lo:[1,0,0] neg_hi:[1,0,0]
  v_pk_fma_f32 v[178:179], v[216:217], v[130:131], v[146:147] op_sel_hi:[0,1,1] neg_lo:[1,0,0] neg_hi:[1,0,0]
  v_pk_fma_f32 v[176:177], v[80:81], v[216:217], v[176:177] op_sel:[0,1,0] op_sel_hi:[1,1,1]
  v_pk_fma_f32 v[178:179], v[82:83], v[216:217], v[178:179] op_sel:[0,1,0] op_sel_hi:[1,1,1]
  v_max_f32 v176, 0, v176
  v_mov_b32 v13, 163832
  v_max_f32 v177, 0, v177
  v_max_f32 v178, 0, v178
  v_max_f32 v179, 0, v179
  v_pk_mul_f32 v[176:177], v[176:177], v[176:177]
  ds_write_b32 v13, v253
  v_pk_mul_f32 v[178:179], v[178:179], v[178:179]
  v_cvt_pk_bf16_f32 v168, v176, v177
  v_cvt_pk_bf16_f32 v169, v178, v179
  v_pk_fma_f32 v[176:177], v[216:217], v[132:133], v[148:149] op_sel_hi:[0,1,1] neg_lo:[1,0,0] neg_hi:[1,0,0]
  v_lshlrev_b32 v2, 4, v1
  v_pk_fma_f32 v[178:179], v[216:217], v[134:135], v[150:151] op_sel_hi:[0,1,1] neg_lo:[1,0,0] neg_hi:[1,0,0]
  v_pk_fma_f32 v[176:177], v[84:85], v[216:217], v[176:177] op_sel:[0,1,0] op_sel_hi:[1,1,1]
  v_pk_fma_f32 v[178:179], v[86:87], v[216:217], v[178:179] op_sel:[0,1,0] op_sel_hi:[1,1,1]
  v_max_f32 v176, 0, v176
  v_mov_b32 v8, 0
  v_max_f32 v177, 0, v177
  v_max_f32 v178, 0, v178
  v_max_f32 v179, 0, v179
  v_pk_mul_f32 v[176:177], v[176:177], v[176:177]
  s_lshl_b32 s77, s87, 31
  v_pk_mul_f32 v[178:179], v[178:179], v[178:179]
  v_cvt_pk_bf16_f32 v170, v176, v177
  v_cvt_pk_bf16_f32 v171, v178, v179
  v_pk_fma_f32 v[176:177], v[216:217], v[136:137], v[152:153] op_sel_hi:[0,1,1] neg_lo:[1,0,0] neg_hi:[1,0,0]
  s_mov_b32 s76, 0
  v_pk_fma_f32 v[178:179], v[216:217], v[138:139], v[154:155] op_sel_hi:[0,1,1] neg_lo:[1,0,0] neg_hi:[1,0,0]
  v_pk_fma_f32 v[176:177], v[88:89], v[216:217], v[176:177] op_sel:[0,1,0] op_sel_hi:[1,1,1]
  v_pk_fma_f32 v[178:179], v[90:91], v[216:217], v[178:179] op_sel:[0,1,0] op_sel_hi:[1,1,1]
  v_max_f32 v176, 0, v176
  s_waitcnt vmcnt(10)
  v_cndmask_b32 v239, v239, v8, s[76:77]
  v_max_f32 v177, 0, v177
  v_max_f32 v178, 0, v178
  v_max_f32 v179, 0, v179
  v_pk_mul_f32 v[176:177], v[176:177], v[176:177]
  s_waitcnt vmcnt(9)
  v_cndmask_b32 v242, v242, v8, s[76:77]
  v_pk_mul_f32 v[178:179], v[178:179], v[178:179]
  v_cvt_pk_bf16_f32 v172, v176, v177
  v_cvt_pk_bf16_f32 v173, v178, v179
  v_pk_fma_f32 v[176:177], v[216:217], v[140:141], v[156:157] op_sel_hi:[0,1,1] neg_lo:[1,0,0] neg_hi:[1,0,0]
  v_cndmask_b32 v243, v243, v8, s[76:77]
  v_pk_fma_f32 v[178:179], v[216:217], v[142:143], v[158:159] op_sel_hi:[0,1,1] neg_lo:[1,0,0] neg_hi:[1,0,0]
  v_pk_fma_f32 v[176:177], v[92:93], v[216:217], v[176:177] op_sel:[0,1,0] op_sel_hi:[1,1,1]
  v_pk_fma_f32 v[178:179], v[94:95], v[216:217], v[178:179] op_sel:[0,1,0] op_sel_hi:[1,1,1]
  v_max_f32 v176, 0, v176
  s_lshl_b32 s37, s87, 11
  v_max_f32 v177, 0, v177
  v_max_f32 v178, 0, v178
  v_max_f32 v179, 0, v179
  v_pk_mul_f32 v[176:177], v[176:177], v[176:177]
  s_add_u32 s37, s37, s88
  v_pk_mul_f32 v[178:179], v[178:179], v[178:179]
  v_cvt_pk_bf16_f32 v174, v176, v177
  v_cvt_pk_bf16_f32 v175, v178, v179
  buffer_store_dwordx4 v[168:171], v12, s[44:47], s83 offen offset:0 sc1
  v_add_u32 v5, s37, v2
  buffer_store_dwordx4 v[172:175], v12, s[44:47], s83 offen offset:1024 sc1
  s_waitcnt lgkmcnt(7)
  v_pk_fma_f32 v[176:177], v[212:213], v[32:33], v[48:49] op_sel_hi:[0,1,1] neg_lo:[1,0,0] neg_hi:[1,0,0]
  v_pk_fma_f32 v[178:179], v[212:213], v[34:35], v[50:51] op_sel_hi:[0,1,1] neg_lo:[1,0,0] neg_hi:[1,0,0]
  v_pk_fma_f32 v[176:177], v[96:97], v[212:213], v[176:177] op_sel:[0,1,0] op_sel_hi:[1,1,1]
  ds_write_b128 v5, v[220:223] offset:0
  v_pk_fma_f32 v[178:179], v[98:99], v[212:213], v[178:179] op_sel:[0,1,0] op_sel_hi:[1,1,1]
  v_max_f32 v176, 0, v176
  v_max_f32 v177, 0, v177
  v_max_f32 v178, 0, v178
  v_alignbit_b32 v16, v224, v220, 16
  v_max_f32 v179, 0, v179
  v_pk_mul_f32 v[176:177], v[176:177], v[176:177]
  v_pk_mul_f32 v[178:179], v[178:179], v[178:179]
  v_cvt_pk_bf16_f32 v160, v176, v177
  v_alignbit_b32 v17, v225, v221, 16
  v_cvt_pk_bf16_f32 v161, v178, v179
  s_waitcnt lgkmcnt(6)
  v_pk_fma_f32 v[176:177], v[212:213], v[36:37], v[52:53] op_sel_hi:[0,1,1] neg_lo:[1,0,0] neg_hi:[1,0,0]
  v_pk_fma_f32 v[178:179], v[212:213], v[38:39], v[54:55] op_sel_hi:[0,1,1] neg_lo:[1,0,0] neg_hi:[1,0,0]
  v_pk_fma_f32 v[176:177], v[100:101], v[212:213], v[176:177] op_sel:[0,1,0] op_sel_hi:[1,1,1]
  v_alignbit_b32 v18, v226, v222, 16
  v_pk_fma_f32 v[178:179], v[102:103], v[212:213], v[178:179] op_sel:[0,1,0] op_sel_hi:[1,1,1]
  v_max_f32 v176, 0, v176
  v_max_f32 v177, 0, v177
  v_max_f32 v178, 0, v178
  v_alignbit_b32 v19, v227, v223, 16
  v_max_f32 v179, 0, v179
  v_pk_mul_f32 v[176:177], v[176:177], v[176:177]
  v_pk_mul_f32 v[178:179], v[178:179], v[178:179]
  v_cvt_pk_bf16_f32 v162, v176, v177
  ds_write_b128 v5, v[224:227] offset:8320
  v_cvt_pk_bf16_f32 v163, v178, v179
  s_waitcnt lgkmcnt(5)
  v_pk_fma_f32 v[176:177], v[212:213], v[40:41], v[56:57] op_sel_hi:[0,1,1] neg_lo:[1,0,0] neg_hi:[1,0,0]
  v_pk_fma_f32 v[178:179], v[212:213], v[42:43], v[58:59] op_sel_hi:[0,1,1] neg_lo:[1,0,0] neg_hi:[1,0,0]
  v_pk_fma_f32 v[176:177], v[104:105], v[212:213], v[176:177] op_sel:[0,1,0] op_sel_hi:[1,1,1]
  v_pk_fma_f32 v[178:179], v[106:107], v[212:213], v[178:179] op_sel:[0,1,0] op_sel_hi:[1,1,1]
  v_alignbit_b32 v20, v228, v224, 16
  v_max_f32 v176, 0, v176
  v_max_f32 v177, 0, v177
  v_max_f32 v178, 0, v178
  v_max_f32 v179, 0, v179
  v_alignbit_b32 v21, v229, v225, 16
  v_pk_mul_f32 v[176:177], v[176:177], v[176:177]
  v_pk_mul_f32 v[178:179], v[178:179], v[178:179]
  v_cvt_pk_bf16_f32 v164, v176, v177
  v_cvt_pk_bf16_f32 v165, v178, v179
  v_alignbit_b32 v22, v230, v226, 16
  s_waitcnt lgkmcnt(3)
  v_pk_fma_f32 v[176:177], v[212:213], v[44:45], v[60:61] op_sel_hi:[0,1,1] neg_lo:[1,0,0] neg_hi:[1,0,0]
  v_pk_fma_f32 v[178:179], v[212:213], v[46:47], v[62:63] op_sel_hi:[0,1,1] neg_lo:[1,0,0] neg_hi:[1,0,0]
  v_pk_fma_f32 v[176:177], v[108:109], v[212:213], v[176:177] op_sel:[0,1,0] op_sel_hi:[1,1,1]
  v_pk_fma_f32 v[178:179], v[110:111], v[212:213], v[178:179] op_sel:[0,1,0] op_sel_hi:[1,1,1]
  v_alignbit_b32 v23, v231, v227, 16
  v_max_f32 v176, 0, v176
  v_max_f32 v177, 0, v177
  v_max_f32 v178, 0, v178
  v_max_f32 v179, 0, v179
  ds_write_b128 v5, v[16:19] offset:4160
  v_pk_mul_f32 v[176:177], v[176:177], v[176:177]
  v_pk_mul_f32 v[178:179], v[178:179], v[178:179]
  v_cvt_pk_bf16_f32 v166, v176, v177
  v_cvt_pk_bf16_f32 v167, v178, v179
  ds_write_b128 v5, v[20:23] offset:12480
  buffer_store_dwordx4 v[160:163], v11, s[44:47], s83 offen offset:2048 sc1
  buffer_store_dwordx4 v[164:167], v11, s[44:47], s83 offen offset:3072 sc1
  v_pk_fma_f32 v[176:177], v[216:217], v[32:33], v[48:49] op_sel_hi:[0,1,1] neg_lo:[1,0,0] neg_hi:[1,0,0]
  v_pk_fma_f32 v[178:179], v[216:217], v[34:35], v[50:51] op_sel_hi:[0,1,1] neg_lo:[1,0,0] neg_hi:[1,0,0]
  ds_write_b128 v5, v[232:235] offset:1024
  v_pk_fma_f32 v[176:177], v[112:113], v[216:217], v[176:177] op_sel:[0,1,0] op_sel_hi:[1,1,1]
  v_pk_fma_f32 v[178:179], v[114:115], v[216:217], v[178:179] op_sel:[0,1,0] op_sel_hi:[1,1,1]
  v_max_f32 v176, 0, v176
  v_max_f32 v177, 0, v177
  v_alignbit_b32 v24, v236, v232, 16
  v_max_f32 v178, 0, v178
  v_max_f32 v179, 0, v179
  v_pk_mul_f32 v[176:177], v[176:177], v[176:177]
  v_pk_mul_f32 v[178:179], v[178:179], v[178:179]
  v_alignbit_b32 v25, v237, v233, 16
  v_cvt_pk_bf16_f32 v168, v176, v177
  v_cvt_pk_bf16_f32 v169, v178, v179
  v_pk_fma_f32 v[176:177], v[216:217], v[36:37], v[52:53] op_sel_hi:[0,1,1] neg_lo:[1,0,0] neg_hi:[1,0,0]
  v_pk_fma_f32 v[178:179], v[216:217], v[38:39], v[54:55] op_sel_hi:[0,1,1] neg_lo:[1,0,0] neg_hi:[1,0,0]
  v_alignbit_b32 v26, v238, v234, 16
  v_pk_fma_f32 v[176:177], v[116:117], v[216:217], v[176:177] op_sel:[0,1,0] op_sel_hi:[1,1,1]
  v_pk_fma_f32 v[178:179], v[118:119], v[216:217], v[178:179] op_sel:[0,1,0] op_sel_hi:[1,1,1]
  v_max_f32 v176, 0, v176
  v_max_f32 v177, 0, v177
  v_alignbit_b32 v27, v239, v235, 16
  v_max_f32 v178, 0, v178
  v_max_f32 v179, 0, v179
  v_pk_mul_f32 v[176:177], v[176:177], v[176:177]
  v_pk_mul_f32 v[178:179], v[178:179], v[178:179]
  ds_write_b128 v5, v[236:239] offset:9344
  v_cvt_pk_bf16_f32 v170, v176, v177
  v_cvt_pk_bf16_f32 v171, v178, v179
  v_pk_fma_f32 v[176:177], v[216:217], v[40:41], v[56:57] op_sel_hi:[0,1,1] neg_lo:[1,0,0] neg_hi:[1,0,0]
  v_pk_fma_f32 v[178:179], v[216:217], v[42:43], v[58:59] op_sel_hi:[0,1,1] neg_lo:[1,0,0] neg_hi:[1,0,0]
  v_alignbit_b32 v28, v240, v236, 16
  v_pk_fma_f32 v[176:177], v[120:121], v[216:217], v[176:177] op_sel:[0,1,0] op_sel_hi:[1,1,1]
  v_pk_fma_f32 v[178:179], v[122:123], v[216:217], v[178:179] op_sel:[0,1,0] op_sel_hi:[1,1,1]
  v_max_f32 v176, 0, v176
  v_max_f32 v177, 0, v177
  v_alignbit_b32 v29, v241, v237, 16
  v_max_f32 v178, 0, v178
  v_max_f32 v179, 0, v179
  v_pk_mul_f32 v[176:177], v[176:177], v[176:177]
  v_pk_mul_f32 v[178:179], v[178:179], v[178:179]
  v_alignbit_b32 v30, v242, v238, 16
  v_cvt_pk_bf16_f32 v172, v176, v177
  v_cvt_pk_bf16_f32 v173, v178, v179
  v_pk_fma_f32 v[176:177], v[216:217], v[44:45], v[60:61] op_sel_hi:[0,1,1] neg_lo:[1,0,0] neg_hi:[1,0,0]
  v_pk_fma_f32 v[178:179], v[216:217], v[46:47], v[62:63] op_sel_hi:[0,1,1] neg_lo:[1,0,0] neg_hi:[1,0,0]
  v_alignbit_b32 v31, v243, v239, 16
  v_pk_fma_f32 v[176:177], v[124:125], v[216:217], v[176:177] op_sel:[0,1,0] op_sel_hi:[1,1,1]
  v_pk_fma_f32 v[178:179], v[126:127], v[216:217], v[178:179] op_sel:[0,1,0] op_sel_hi:[1,1,1]
  v_max_f32 v176, 0, v176
  v_max_f32 v177, 0, v177
  ds_write_b128 v5, v[24:27] offset:5184
  v_max_f32 v178, 0, v178
  v_max_f32 v179, 0, v179
  v_pk_mul_f32 v[176:177], v[176:177], v[176:177]
  v_pk_mul_f32 v[178:179], v[178:179], v[178:179]
  ds_write_b128 v5, v[28:31] offset:13504
  v_cvt_pk_bf16_f32 v174, v176, v177
  v_cvt_pk_bf16_f32 v175, v178, v179
  buffer_store_dwordx4 v[168:171], v12, s[44:47], s83 offen offset:2048 sc1
  buffer_store_dwordx4 v[172:175], v12, s[44:47], s83 offen offset:3072 sc1
  s_waitcnt vmcnt(8)
fz_cfill:
  v_and_b32 v10, 15, v1
  v_lshrrev_b32 v11, 4, v1
  v_lshrrev_b32 v12, 1, v11
  v_and_b32 v11, 1, v11
  v_lshrrev_b32 v13, 2, v10
  v_lshl_add_u32 v12, v12, 2, v13
  v_lshlrev_b32 v12, 7, v12
  v_and_b32 v14, 3, v10
  v_lshrrev_b32 v15, 1, v14
  v_lshl_add_u32 v12, v15, 3, v12
  v_and_b32 v14, 1, v14
  v_lshl_add_u32 v14, v14, 1, v11
  v_lshrrev_b32 v15, 3, v10
  v_lshlrev_b32 v15, 2, v15
  v_add_u32 v12, s17, v12
  v_add_u32 v13, 0, v14
  v_xor_b32 v13, v13, v15
  v_lshl_add_u32 v60, v13, 4, v12
  v_add_u32 v62, 0x10000, v60
  v_add_u32 v13, 4, v14
  v_xor_b32 v13, v13, v15
  v_lshl_add_u32 v61, v13, 4, v12
  v_add_u32 v63, 0x10000, v61
  v_and_b32 v6, 15, v1
  v_lshrrev_b32 v7, 4, v1
  v_sub_u32 v14, 3, v6
  v_and_b32 v14, 3, v14
  v_mul_u32_u24 v15, 4158, v14
  v_lshlrev_b32 v14, 1, v6
  v_sub_u32 v15, v15, v14
  v_lshl_add_u32 v15, v7, 4, v15
  s_lshl_b32 s37, s87, 8
  s_sub_u32 s37, s88, s37
  s_add_u32 s38, s37, 30
  v_add_u32 v12, s38, v15
  v_lshlrev_b32 v15, 5, v6
  v_lshl_add_u32 v15, v7, 4, v15
  s_add_u32 s38, s37, 16672
  v_add_u32 v13, s38, v15
  s_waitcnt lgkmcnt(0)
  s_barrier
  ds_read_b64 v[96:97], v12 offset:4032
  ds_read_b64 v[98:99], v12 offset:4040
  ds_read_b128 v[160:163], v13 offset:448
  ds_read_b64 v[100:101], v12 offset:3520
  ds_read_b64 v[102:103], v12 offset:3528
  ds_read_b128 v[164:167], v13 offset:960
  ds_read_b64 v[104:105], v12 offset:3008
  ds_read_b64 v[106:107], v12 offset:3016
  ds_read_b128 v[168:171], v13 offset:1472
  ds_read_b64 v[108:109], v12 offset:2496
  ds_read_b64 v[110:111], v12 offset:2504
  ds_read_b128 v[172:175], v13 offset:1984
  ds_read_b64 v[112:113], v12 offset:1984
  ds_read_b64 v[114:115], v12 offset:1992
  ds_read_b128 v[176:179], v13 offset:2496
  ds_read_b64 v[116:117], v12 offset:1472
  ds_read_b64 v[118:119], v12 offset:1480
  ds_read_b128 v[180:183], v13 offset:3008
  ds_read_b64 v[120:121], v12 offset:960
  ds_read_b64 v[122:123], v12 offset:968
  ds_read_b128 v[184:187], v13 offset:3520
  ds_read_b64 v[124:125], v12 offset:448
  ds_read_b64 v[126:127], v12 offset:456
  ds_read_b128 v[188:191], v13 offset:4032
  s_waitcnt lgkmcnt(15)
  v_mfma_f32_16x16x32_bf16 v[64:67], v[96:99], v[160:163], 0
  ds_read_b64 v[128:129], v12 offset:3968
  ds_read_b64_tr_b16 a[0:1], v60 offset:0
  v_mfma_f32_16x16x32_bf16 v[68:71], v[96:99], v[164:167], 0
  ds_read_b64 v[130:131], v12 offset:3976
  ds_read_b64_tr_b16 a[2:3], v60 offset:1024
  v_mfma_f32_16x16x32_bf16 v[68:71], v[100:103], v[160:163], v[68:71]
  ds_read_b128 v[192:195], v13 offset:384
  v_mfma_f32_16x16x32_bf16 v[72:75], v[100:103], v[164:167], 0
  ds_read_b64 v[132:133], v12 offset:3456
  ds_read_b64_tr_b16 a[4:5], v61 offset:0
  v_mfma_f32_16x16x32_bf16 v[72:75], v[96:99], v[168:171], v[72:75]
  ds_read_b64_tr_b16 a[6:7], v61 offset:1024
  v_mfma_f32_16x16x32_bf16 v[76:79], v[100:103], v[168:171], 0
  ds_read_b64 v[134:135], v12 offset:3464
  v_mfma_f32_16x16x32_bf16 v[72:75], v[104:107], v[160:163], v[72:75]
  ds_read_b128 v[196:199], v13 offset:896
  ds_read_b64_tr_b16 a[8:9], v60 offset:8192
  v_mfma_f32_16x16x32_bf16 v[76:79], v[104:107], v[164:167], v[76:79]
  ds_read_b64 v[136:137], v12 offset:2944
  ds_read_b64_tr_b16 a[10:11], v60 offset:9216
  v_mfma_f32_16x16x32_bf16 v[80:83], v[104:107], v[168:171], 0
  ds_read_b64 v[138:139], v12 offset:2952
  s_waitcnt lgkmcnt(15)
  v_mfma_f32_16x16x32_bf16 v[76:79], v[96:99], v[172:175], v[76:79]
  ds_read_b64_tr_b16 a[12:13], v61 offset:8192
  v_mfma_f32_16x16x32_bf16 v[80:83], v[100:103], v[172:175], v[80:83]
  ds_read_b128 v[200:203], v13 offset:1408
  ds_read_b64_tr_b16 a[14:15], v61 offset:9216
  v_mfma_f32_16x16x32_bf16 v[84:87], v[104:107], v[172:175], 0
  ds_read_b64 v[140:141], v12 offset:2432
  v_mfma_f32_16x16x32_bf16 v[76:79], v[108:111], v[160:163], v[76:79]
  ds_read_b64 v[142:143], v12 offset:2440
  ds_read_b64_tr_b16 a[16:17], v60 offset:16384
  v_mfma_f32_16x16x32_bf16 v[80:83], v[108:111], v[164:167], v[80:83]
  ds_read_b128 v[204:207], v13 offset:1920
  ds_read_b64_tr_b16 a[18:19], v60 offset:17408
  v_mfma_f32_16x16x32_bf16 v[84:87], v[108:111], v[168:171], v[84:87]
  v_mfma_f32_16x16x32_bf16 v[88:91], v[108:111], v[172:175], 0
  ds_read_b64 v[144:145], v12 offset:1920
  ds_read_b64_tr_b16 a[20:21], v61 offset:16384
  v_mfma_f32_16x16x32_bf16 v[80:83], v[96:99], v[176:179], v[80:83]
  ds_read_b64 v[146:147], v12 offset:1928
  ds_read_b64_tr_b16 a[22:23], v61 offset:17408
  v_mfma_f32_16x16x32_bf16 v[84:87], v[100:103], v[176:179], v[84:87]
  ds_read_b128 v[208:211], v13 offset:2432
  v_mfma_f32_16x16x32_bf16 v[88:91], v[104:107], v[176:179], v[88:91]
  ds_read_b64 v[148:149], v12 offset:1408
  ds_read_b64_tr_b16 a[24:25], v60 offset:24576
  v_mfma_f32_16x16x32_bf16 v[92:95], v[108:111], v[176:179], 0
  ds_read_b64_tr_b16 a[26:27], v60 offset:25600
  v_mfma_f32_16x16x32_bf16 v[80:83], v[112:115], v[160:163], v[80:83]
  ds_read_b64 v[150:151], v12 offset:1416
  v_mfma_f32_16x16x32_bf16 v[84:87], v[112:115], v[164:167], v[84:87]
  ds_read_b128 v[212:215], v13 offset:2944
  ds_read_b64_tr_b16 a[28:29], v61 offset:24576
  v_mfma_f32_16x16x32_bf16 v[88:91], v[112:115], v[168:171], v[88:91]
  ds_read_b64 v[152:153], v12 offset:896
  ds_read_b64_tr_b16 a[30:31], v61 offset:25600
  v_mfma_f32_16x16x32_bf16 v[92:95], v[112:115], v[172:175], v[92:95]
  ds_read_b64 v[154:155], v12 offset:904
  v_mfma_f32_16x16x32_bf16 v[84:87], v[96:99], v[180:183], v[84:87]
  ds_read_b64_tr_b16 a[32:33], v60 offset:32768
  v_mfma_f32_16x16x32_bf16 v[88:91], v[100:103], v[180:183], v[88:91]
  ds_read_b128 v[216:219], v13 offset:3456
  ds_read_b64_tr_b16 a[34:35], v60 offset:33792
  v_mfma_f32_16x16x32_bf16 v[92:95], v[104:107], v[180:183], v[92:95]
  ds_read_b64 v[156:157], v12 offset:384
  v_mfma_f32_16x16x32_bf16 v[84:87], v[116:119], v[160:163], v[84:87]
  ds_read_b64 v[158:159], v12 offset:392
  ds_read_b64_tr_b16 a[36:37], v61 offset:32768
  v_mfma_f32_16x16x32_bf16 v[88:91], v[116:119], v[164:167], v[88:91]
  ds_read_b128 v[220:223], v13 offset:3968
  ds_read_b64_tr_b16 a[38:39], v61 offset:33792
  v_mfma_f32_16x16x32_bf16 v[92:95], v[116:119], v[168:171], v[92:95]
  v_mfma_f32_16x16x32_bf16 v[88:91], v[96:99], v[184:187], v[88:91]
  ds_read_b64_tr_b16 a[40:41], v60 offset:40960
  v_mfma_f32_16x16x32_bf16 v[92:95], v[100:103], v[184:187], v[92:95]
  ds_read_b64_tr_b16 a[42:43], v60 offset:41984
  v_mfma_f32_16x16x32_bf16 v[88:91], v[120:123], v[160:163], v[88:91]
  v_mfma_f32_16x16x32_bf16 v[92:95], v[120:123], v[164:167], v[92:95]
  ds_read_b64_tr_b16 a[44:45], v61 offset:40960
  s_waitcnt lgkmcnt(15)
  v_mfma_f32_16x16x32_bf16 v[92:95], v[96:99], v[188:191], v[92:95]
  ds_read_b64_tr_b16 a[46:47], v61 offset:41984
  v_mfma_f32_16x16x32_bf16 v[92:95], v[124:127], v[160:163], v[92:95]
  s_waitcnt vmcnt(0)
  s_cmp_ge_u32 s34, 28
  s_cbranch_scc1 fz_nohp
  s_lshl_b32 s36, s73, 1
  s_lshr_b32 s37, s35, 1
  s_add_u32 s36, s36, s37
  s_mul_i32 s36, s36, 28
  s_lshl_b32 s37, s74, 1
  s_add_u32 s36, s36, s37
  s_and_b32 s37, s35, 1
  s_add_u32 s36, s36, s37
  s_lshl_b32 s36, s36, 7
  s_add_u32 s36, s36, 32768
  v_mov_b32 v252, s32
  v_mov_b32 v253, 0
  s_mov_b64 exec, 1
  buffer_store_dword v252, v253, s[96:99], s36 offen sc1
  s_mov_b64 exec, -1
fz_nohp:
  s_waitcnt lgkmcnt(0)
  s_nop 2
  v_mfma_f32_16x16x32_bf16 v[64:67], v[128:131], v[192:195], v[64:67]
  ds_read_b64 v[96:97], v12 offset:3904
  ds_read_b64_tr_b16 a[48:49], v60 offset:49152
  v_mfma_f32_16x16x32_bf16 v[68:71], v[128:131], v[196:199], v[68:71]
  ds_read_b64 v[98:99], v12 offset:3912
  ds_read_b64_tr_b16 a[50:51], v60 offset:50176
  v_mfma_f32_16x16x32_bf16 v[68:71], v[132:135], v[192:195], v[68:71]
  ds_read_b128 v[160:163], v13 offset:320
  ds_read_b64_tr_b16 a[52:53], v61 offset:49152
  v_mfma_f32_16x16x32_bf16 v[72:75], v[132:135], v[196:199], v[72:75]
  ds_read_b64 v[100:101], v12 offset:3392
  ds_read_b64_tr_b16 a[54:55], v61 offset:50176
  v_mfma_f32_16x16x32_bf16 v[72:75], v[128:131], v[200:203], v[72:75]
  s_add_u32 m0, s17, 0
  s_add_u32 s75, s3, 393216
  buffer_load_dwordx4 v246, s[8:11], s75 offen lds
  buffer_load_dwordx4 v247, s[8:11], s75 offen offset:1024 lds
  v_mfma_f32_16x16x32_bf16 v[76:79], v[132:135], v[200:203], v[76:79]
  ds_read_b64 v[102:103], v12 offset:3400
  v_mfma_f32_16x16x32_bf16 v[72:75], v[136:139], v[192:195], v[72:75]
  ds_read_b128 v[164:167], v13 offset:832
  ds_read_b64_tr_b16 a[56:57], v60 offset:57344
  v_mfma_f32_16x16x32_bf16 v[76:79], v[136:139], v[196:199], v[76:79]
  ds_read_b64 v[104:105], v12 offset:2880
  ds_read_b64_tr_b16 a[58:59], v60 offset:58368
  v_mfma_f32_16x16x32_bf16 v[80:83], v[136:139], v[200:203], v[80:83]
  ds_read_b64 v[106:107], v12 offset:2888
  ds_read_b64_tr_b16 a[60:61], v61 offset:57344
  v_mfma_f32_16x16x32_bf16 v[76:79], v[128:131], v[204:207], v[76:79]
  ds_read_b64_tr_b16 a[62:63], v61 offset:58368
  v_mfma_f32_16x16x32_bf16 v[80:83], v[132:135], v[204:207], v[80:83]
  ds_read_b128 v[168:171], v13 offset:1344
  s_add_u32 m0, s17, 8192
  s_add_u32 s75, s3, 409600
  buffer_load_dwordx4 v246, s[8:11], s75 offen lds
  buffer_load_dwordx4 v247, s[8:11], s75 offen offset:1024 lds
  v_mfma_f32_16x16x32_bf16 v[84:87], v[136:139], v[204:207], v[84:87]
  ds_read_b64 v[108:109], v12 offset:2368
  v_mfma_f32_16x16x32_bf16 v[76:79], v[140:143], v[192:195], v[76:79]
  ds_read_b64 v[110:111], v12 offset:2376
  ds_read_b64_tr_b16 a[64:65], v62 offset:0
  v_mfma_f32_16x16x32_bf16 v[80:83], v[140:143], v[196:199], v[80:83]
  ds_read_b128 v[172:175], v13 offset:1856
  ds_read_b64_tr_b16 a[66:67], v62 offset:1024
  v_mfma_f32_16x16x32_bf16 v[84:87], v[140:143], v[200:203], v[84:87]
  ds_read_b64_tr_b16 a[68:69], v63 offset:0
  v_mfma_f32_16x16x32_bf16 v[88:91], v[140:143], v[204:207], v[88:91]
  ds_read_b64 v[112:113], v12 offset:1856
  ds_read_b64_tr_b16 a[70:71], v63 offset:1024
  v_mfma_f32_16x16x32_bf16 v[80:83], v[128:131], v[208:211], v[80:83]
  ds_read_b64 v[114:115], v12 offset:1864
  s_add_u32 m0, s17, 16384
  s_add_u32 s75, s3, 425984
  buffer_load_dwordx4 v246, s[8:11], s75 offen lds
  buffer_load_dwordx4 v247, s[8:11], s75 offen offset:1024 lds
  v_mfma_f32_16x16x32_bf16 v[84:87], v[132:135], v[208:211], v[84:87]
  ds_read_b128 v[176:179], v13 offset:2368
  v_mfma_f32_16x16x32_bf16 v[88:91], v[136:139], v[208:211], v[88:91]
  ds_read_b64 v[116:117], v12 offset:1344
  ds_read_b64_tr_b16 a[72:73], v62 offset:8192
  v_mfma_f32_16x16x32_bf16 v[92:95], v[140:143], v[208:211], v[92:95]
  ds_read_b64_tr_b16 a[74:75], v62 offset:9216
  v_mfma_f32_16x16x32_bf16 v[80:83], v[144:147], v[192:195], v[80:83]
  ds_read_b64 v[118:119], v12 offset:1352
  ds_read_b64_tr_b16 a[76:77], v63 offset:8192
  v_mfma_f32_16x16x32_bf16 v[84:87], v[144:147], v[196:199], v[84:87]
  ds_read_b128 v[180:183], v13 offset:2880
  ds_read_b64_tr_b16 a[78:79], v63 offset:9216
  v_mfma_f32_16x16x32_bf16 v[88:91], v[144:147], v[200:203], v[88:91]
  ds_read_b64 v[120:121], v12 offset:832
  s_add_u32 m0, s17, 24576
  s_add_u32 s75, s3, 442368
  buffer_load_dwordx4 v246, s[8:11], s75 offen lds
  buffer_load_dwordx4 v247, s[8:11], s75 offen offset:1024 lds
  v_mfma_f32_16x16x32_bf16 v[92:95], v[144:147], v[204:207], v[92:95]
  ds_read_b64 v[122:123], v12 offset:840
  v_mfma_f32_16x16x32_bf16 v[84:87], v[128:131], v[212:215], v[84:87]
  ds_read_b64_tr_b16 a[80:81], v62 offset:16384
  v_mfma_f32_16x16x32_bf16 v[88:91], v[132:135], v[212:215], v[88:91]
  ds_read_b128 v[184:187], v13 offset:3392
  ds_read_b64_tr_b16 a[82:83], v62 offset:17408
  v_mfma_f32_16x16x32_bf16 v[92:95], v[136:139], v[212:215], v[92:95]
  ds_read_b64 v[124:125], v12 offset:320
  ds_read_b64_tr_b16 a[84:85], v63 offset:16384
  v_mfma_f32_16x16x32_bf16 v[84:87], v[148:151], v[192:195], v[84:87]
  ds_read_b64 v[126:127], v12 offset:328
  ds_read_b64_tr_b16 a[86:87], v63 offset:17408
  v_mfma_f32_16x16x32_bf16 v[88:91], v[148:151], v[196:199], v[88:91]
  ds_read_b128 v[188:191], v13 offset:3904
  s_add_u32 m0, s17, 32768
  s_add_u32 s75, s3, 65536
  buffer_load_dwordx4 v246, s[8:11], s75 offen lds
  buffer_load_dwordx4 v247, s[8:11], s75 offen offset:1024 lds
  v_mfma_f32_16x16x32_bf16 v[92:95], v[148:151], v[200:203], v[92:95]
  v_mfma_f32_16x16x32_bf16 v[88:91], v[128:131], v[216:219], v[88:91]
  ds_read_b64_tr_b16 a[88:89], v62 offset:24576
  v_mfma_f32_16x16x32_bf16 v[92:95], v[132:135], v[216:219], v[92:95]
  ds_read_b64_tr_b16 a[90:91], v62 offset:25600
  v_mfma_f32_16x16x32_bf16 v[88:91], v[152:155], v[192:195], v[88:91]
  ds_read_b64_tr_b16 a[92:93], v63 offset:24576
  v_mfma_f32_16x16x32_bf16 v[92:95], v[152:155], v[196:199], v[92:95]
  ds_read_b64_tr_b16 a[94:95], v63 offset:25600
  v_mfma_f32_16x16x32_bf16 v[92:95], v[128:131], v[220:223], v[92:95]
  s_add_u32 m0, s17, 40960
  s_add_u32 s75, s3, 81920
  buffer_load_dwordx4 v246, s[8:11], s75 offen lds
  buffer_load_dwordx4 v247, s[8:11], s75 offen offset:1024 lds
  v_mfma_f32_16x16x32_bf16 v[92:95], v[156:159], v[192:195], v[92:95]
  s_waitcnt lgkmcnt(0)
  v_mfma_f32_16x16x32_bf16 v[64:67], v[96:99], v[160:163], v[64:67]
  ds_read_b64 v[128:129], v12 offset:3840
  s_add_u32 m0, s17, 49152
  s_add_u32 s75, s3, 98304
  buffer_load_dwordx4 v246, s[8:11], s75 offen lds
  buffer_load_dwordx4 v247, s[8:11], s75 offen offset:1024 lds
  v_mfma_f32_16x16x32_bf16 v[68:71], v[96:99], v[164:167], v[68:71]
  ds_read_b64 v[130:131], v12 offset:3848
  s_add_u32 m0, s17, 57344
  s_add_u32 s75, s3, 114688
  buffer_load_dwordx4 v246, s[8:11], s75 offen lds
  buffer_load_dwordx4 v247, s[8:11], s75 offen offset:1024 lds
  v_mfma_f32_16x16x32_bf16 v[68:71], v[100:103], v[160:163], v[68:71]
  ds_read_b128 v[192:195], v13 offset:256
  v_mfma_f32_16x16x32_bf16 v[72:75], v[100:103], v[164:167], v[72:75]
  ds_read_b64 v[132:133], v12 offset:3328
  s_add_u32 m0, s17, 65536
  s_add_u32 s75, s3, 131072
  buffer_load_dwordx4 v246, s[8:11], s75 offen lds
  buffer_load_dwordx4 v247, s[8:11], s75 offen offset:1024 lds
  v_mfma_f32_16x16x32_bf16 v[72:75], v[96:99], v[168:171], v[72:75]
  s_add_u32 m0, s17, 73728
  s_add_u32 s75, s3, 147456
  buffer_load_dwordx4 v246, s[8:11], s75 offen lds
  buffer_load_dwordx4 v247, s[8:11], s75 offen offset:1024 lds
  v_mfma_f32_16x16x32_bf16 v[76:79], v[100:103], v[168:171], v[76:79]
  ds_read_b64 v[134:135], v12 offset:3336
  v_mfma_f32_16x16x32_bf16 v[72:75], v[104:107], v[160:163], v[72:75]
  ds_read_b128 v[196:199], v13 offset:768
  s_add_u32 m0, s17, 81920
  s_add_u32 s75, s3, 163840
  buffer_load_dwordx4 v246, s[8:11], s75 offen lds
  buffer_load_dwordx4 v247, s[8:11], s75 offen offset:1024 lds
  v_mfma_f32_16x16x32_bf16 v[76:79], v[104:107], v[164:167], v[76:79]
  ds_read_b64 v[136:137], v12 offset:2816
  s_add_u32 m0, s17, 90112
  s_add_u32 s75, s3, 180224
  buffer_load_dwordx4 v246, s[8:11], s75 offen lds
  buffer_load_dwordx4 v247, s[8:11], s75 offen offset:1024 lds
  v_mfma_f32_16x16x32_bf16 v[80:83], v[104:107], v[168:171], v[80:83]
  ds_read_b64 v[138:139], v12 offset:2824
  v_mfma_f32_16x16x32_bf16 v[76:79], v[96:99], v[172:175], v[76:79]
  s_add_u32 s60, s30, 0xa00000
  s_addc_u32 s61, s31, 0
  s_mov_b32 s62, 0x200000
  s_mov_b32 s63, 0x20000
  v_mfma_f32_16x16x32_bf16 v[80:83], v[100:103], v[172:175], v[80:83]
  ds_read_b128 v[200:203], v13 offset:1280
  v_lshlrev_b32 v2, 4, v1
  v_mfma_f32_16x16x32_bf16 v[84:87], v[104:107], v[172:175], v[84:87]
  ds_read_b64 v[140:141], v12 offset:2304
  v_mfma_f32_16x16x32_bf16 v[76:79], v[108:111], v[160:163], v[76:79]
  ds_read_b64 v[142:143], v12 offset:2312
  s_lshl_b32 s37, s35, 12
  v_mfma_f32_16x16x32_bf16 v[80:83], v[108:111], v[164:167], v[80:83]
  ds_read_b128 v[204:207], v13 offset:1792
  v_add_u32 v5, s37, v2
  v_mfma_f32_16x16x32_bf16 v[84:87], v[108:111], v[168:171], v[84:87]
  v_mfma_f32_16x16x32_bf16 v[88:91], v[108:111], v[172:175], v[88:91]
  ds_read_b64 v[144:145], v12 offset:1792
  v_add_u32 v5, 141056, v5
  v_mfma_f32_16x16x32_bf16 v[80:83], v[96:99], v[176:179], v[80:83]
  ds_read_b64 v[146:147], v12 offset:1800
  s_xor_b32 s37, s35, 1
  v_mfma_f32_16x16x32_bf16 v[84:87], v[100:103], v[176:179], v[84:87]
  ds_read_b128 v[208:211], v13 offset:2304
  v_mfma_f32_16x16x32_bf16 v[88:91], v[104:107], v[176:179], v[88:91]
  ds_read_b64 v[148:149], v12 offset:1280
  s_lshl_b32 s37, s37, 12
  v_mfma_f32_16x16x32_bf16 v[92:95], v[108:111], v[176:179], v[92:95]
  v_add_u32 v14, s37, v2
  v_mfma_f32_16x16x32_bf16 v[80:83], v[112:115], v[160:163], v[80:83]
  ds_read_b64 v[150:151], v12 offset:1288
  v_mfma_f32_16x16x32_bf16 v[84:87], v[112:115], v[164:167], v[84:87]
  ds_read_b128 v[212:215], v13 offset:2816
  v_add_u32 v14, 141056, v14
  v_mfma_f32_16x16x32_bf16 v[88:91], v[112:115], v[168:171], v[88:91]
  ds_read_b64 v[152:153], v12 offset:768
  v_lshlrev_b32 v15, 5, v6
  v_mfma_f32_16x16x32_bf16 v[92:95], v[112:115], v[172:175], v[92:95]
  ds_read_b64 v[154:155], v12 offset:776
  v_mfma_f32_16x16x32_bf16 v[84:87], v[96:99], v[180:183], v[84:87]
  v_lshl_add_u32 v15, v7, 3, v15
  v_mfma_f32_16x16x32_bf16 v[88:91], v[100:103], v[180:183], v[88:91]
  ds_read_b128 v[216:219], v13 offset:3328
  s_lshl_b32 s37, s87, 11
  v_mfma_f32_16x16x32_bf16 v[92:95], v[104:107], v[180:183], v[92:95]
  ds_read_b64 v[156:157], v12 offset:256
  v_mfma_f32_16x16x32_bf16 v[84:87], v[116:119], v[160:163], v[84:87]
  ds_read_b64 v[158:159], v12 offset:264
  s_sub_u32 s38, s88, s37
  v_mfma_f32_16x16x32_bf16 v[88:91], v[116:119], v[164:167], v[88:91]
  ds_read_b128 v[220:223], v13 offset:3840
  s_add_u32 s38, s38, 2552
  v_mfma_f32_16x16x32_bf16 v[92:95], v[116:119], v[168:171], v[92:95]
  v_mfma_f32_16x16x32_bf16 v[88:91], v[96:99], v[184:187], v[88:91]
  v_sub_u32 v16, s38, v15
  v_mfma_f32_16x16x32_bf16 v[92:95], v[100:103], v[184:187], v[92:95]
  s_lshl_b32 s84, s86, 12
  v_mfma_f32_16x16x32_bf16 v[88:91], v[120:123], v[160:163], v[88:91]
  v_mfma_f32_16x16x32_bf16 v[92:95], v[120:123], v[164:167], v[92:95]
  s_add_u32 s84, s84, s37
  v_mfma_f32_16x16x32_bf16 v[92:95], v[96:99], v[188:191], v[92:95]
  v_lshlrev_b32 v254, 16, v254
  v_mfma_f32_16x16x32_bf16 v[92:95], v[124:127], v[160:163], v[92:95]
  s_waitcnt lgkmcnt(0)
  s_waitcnt vmcnt(16)
  v_mfma_f32_16x16x32_bf16 v[64:67], v[128:131], v[192:195], v[64:67]
  ds_read_b64_tr_b16 a[96:97], v60 offset:0
  v_mfma_f32_16x16x32_bf16 v[68:71], v[128:131], v[196:199], v[68:71]
  ds_read_b64_tr_b16 a[98:99], v60 offset:1024
  v_mfma_f32_16x16x32_bf16 v[68:71], v[132:135], v[192:195], v[68:71]
  ds_read_b64_tr_b16 a[100:101], v61 offset:0
  v_mfma_f32_16x16x32_bf16 v[72:75], v[132:135], v[196:199], v[72:75]
  v_mfma_f32_16x16x32_bf16 v[72:75], v[128:131], v[200:203], v[72:75]
  ds_read_b64_tr_b16 a[102:103], v61 offset:1024
  v_mfma_f32_16x16x32_bf16 v[76:79], v[132:135], v[200:203], v[76:79]
  ds_read_b64_tr_b16 a[104:105], v60 offset:8192
  v_mfma_f32_16x16x32_bf16 v[72:75], v[136:139], v[192:195], v[72:75]
  v_mfma_f32_16x16x32_bf16 v[76:79], v[136:139], v[196:199], v[76:79]
  ds_read_b64_tr_b16 a[106:107], v60 offset:9216
  v_mfma_f32_16x16x32_bf16 v[80:83], v[136:139], v[200:203], v[80:83]
  ds_read_b64_tr_b16 a[108:109], v61 offset:8192
  v_mfma_f32_16x16x32_bf16 v[76:79], v[128:131], v[204:207], v[76:79]
  v_mfma_f32_16x16x32_bf16 v[80:83], v[132:135], v[204:207], v[80:83]
  ds_read_b64_tr_b16 a[110:111], v61 offset:9216
  v_mfma_f32_16x16x32_bf16 v[84:87], v[136:139], v[204:207], v[84:87]
  ds_read_b64_tr_b16 a[112:113], v60 offset:16384
  v_mfma_f32_16x16x32_bf16 v[76:79], v[140:143], v[192:195], v[76:79]
  ds_read_b64_tr_b16 a[114:115], v60 offset:17408
  v_mfma_f32_16x16x32_bf16 v[80:83], v[140:143], v[196:199], v[80:83]
  v_mfma_f32_16x16x32_bf16 v[84:87], v[140:143], v[200:203], v[84:87]
  ds_read_b64_tr_b16 a[116:117], v61 offset:16384
  v_mfma_f32_16x16x32_bf16 v[88:91], v[140:143], v[204:207], v[88:91]
  ds_read_b64_tr_b16 a[118:119], v61 offset:17408
  v_mfma_f32_16x16x32_bf16 v[80:83], v[128:131], v[208:211], v[80:83]
  v_mfma_f32_16x16x32_bf16 v[84:87], v[132:135], v[208:211], v[84:87]
  ds_read_b64_tr_b16 a[120:121], v60 offset:24576
  v_mfma_f32_16x16x32_bf16 v[88:91], v[136:139], v[208:211], v[88:91]
  ds_read_b64_tr_b16 a[122:123], v60 offset:25600
  v_mfma_f32_16x16x32_bf16 v[92:95], v[140:143], v[208:211], v[92:95]
  v_mfma_f32_16x16x32_bf16 v[80:83], v[144:147], v[192:195], v[80:83]
  ds_read_b64_tr_b16 a[124:125], v61 offset:24576
  v_mfma_f32_16x16x32_bf16 v[84:87], v[144:147], v[196:199], v[84:87]
  ds_read_b64_tr_b16 a[126:127], v61 offset:25600
  v_mfma_f32_16x16x32_bf16 v[88:91], v[144:147], v[200:203], v[88:91]
  v_mfma_f32_16x16x32_bf16 v[92:95], v[144:147], v[204:207], v[92:95]
  v_min_u32 v249, 6, v1
  v_mfma_f32_16x16x32_bf16 v[84:87], v[128:131], v[212:215], v[84:87]
  v_lshlrev_b32 v249, 7, v249
  v_mfma_f32_16x16x32_bf16 v[88:91], v[132:135], v[212:215], v[88:91]
  s_lshr_b32 s83, s89, 6
  v_mfma_f32_16x16x32_bf16 v[92:95], v[136:139], v[212:215], v[92:95]
  v_mfma_f32_16x16x32_bf16 v[84:87], v[148:151], v[192:195], v[84:87]
  s_mul_i32 s83, s83, 28
  v_mfma_f32_16x16x32_bf16 v[88:91], v[148:151], v[196:199], v[88:91]
  s_mul_i32 s36, s35, 7
  v_mfma_f32_16x16x32_bf16 v[92:95], v[148:151], v[200:203], v[92:95]
  v_mfma_f32_16x16x32_bf16 v[88:91], v[128:131], v[216:219], v[88:91]
  s_add_u32 s83, s83, s36
  v_mfma_f32_16x16x32_bf16 v[92:95], v[132:135], v[216:219], v[92:95]
  s_lshl_b32 s83, s83, 7
  v_mfma_f32_16x16x32_bf16 v[88:91], v[152:155], v[192:195], v[88:91]
  v_mfma_f32_16x16x32_bf16 v[92:95], v[152:155], v[196:199], v[92:95]
  s_add_u32 s83, s83, 32768
  v_mfma_f32_16x16x32_bf16 v[92:95], v[128:131], v[220:223], v[92:95]
  buffer_load_dword v248, v249, s[96:99], s83 offen sc1
  v_mfma_f32_16x16x32_bf16 v[92:95], v[156:159], v[192:195], v[92:95]
  s_waitcnt lgkmcnt(0)
  s_add_u32 m0, s17, 0
  s_add_u32 s75, s3, 0
  buffer_load_dwordx4 v246, s[8:11], s75 offen lds
  buffer_load_dwordx4 v247, s[8:11], s75 offen offset:1024 lds
  s_add_u32 m0, s17, 8192
  s_add_u32 s75, s3, 16384
  buffer_load_dwordx4 v246, s[8:11], s75 offen lds
  buffer_load_dwordx4 v247, s[8:11], s75 offen offset:1024 lds
  s_add_u32 m0, s17, 16384
  s_add_u32 s75, s3, 32768
  buffer_load_dwordx4 v246, s[8:11], s75 offen lds
  buffer_load_dwordx4 v247, s[8:11], s75 offen offset:1024 lds
  s_add_u32 m0, s17, 24576
  s_add_u32 s75, s3, 49152
  buffer_load_dwordx4 v246, s[8:11], s75 offen lds
  buffer_load_dwordx4 v247, s[8:11], s75 offen offset:1024 lds
  s_mov_b32 s40, s30
  s_mov_b32 s41, s31
  s_mov_b32 s42, 0x700000
  s_mov_b32 s43, 0x20000
  s_waitcnt vmcnt(8)
  v_cmp_ne_u32 vcc, s32, v248
  s_nop 4
  s_cbranch_vccz Lp5_ok
  s_mov_b32 s79, 0
Lp5_loop:
  s_sleep 2
  buffer_load_dword v248, v249, s[96:99], s83 offen sc1
  s_waitcnt vmcnt(0)
  v_cmp_ne_u32 vcc, s32, v248
  s_nop 4
  s_cbranch_vccz Lp5_ok
  s_add_u32 s79, s79, 1
  s_cmp_lt_u32 s79, 0x40000
  s_cbranch_scc1 Lp5_loop
Lp5_ok:
  s_add_u32 s7, s91, 12288
  buffer_load_dwordx4 a[128:131], v244, s[40:43], s7 offen sc1
  buffer_load_dwordx4 a[132:135], v245, s[40:43], s7 offen sc1
  s_add_u32 s7, s91, 13312
  buffer_load_dwordx4 a[136:139], v244, s[40:43], s7 offen sc1
  buffer_load_dwordx4 a[140:143], v245, s[40:43], s7 offen sc1
  ds_read_b64 v[36:37], v16 offset:1536
  ds_read_b64 v[38:39], v16 offset:1024
  ds_read_b64 v[40:41], v16 offset:512
  ds_read_b64 v[42:43], v16 offset:0
  s_add_u32 s7, s91, 14336
  buffer_load_dwordx4 a[144:147], v244, s[40:43], s7 offen sc1
  buffer_load_dwordx4 a[148:151], v245, s[40:43], s7 offen sc1
  s_add_u32 s7, s91, 15360
  buffer_load_dwordx4 a[152:155], v244, s[40:43], s7 offen sc1
  buffer_load_dwordx4 a[156:159], v245, s[40:43], s7 offen sc1
  s_cmp_eq_u32 s87, 0
  s_cbranch_scc0 fz_hi
  ds_write_b128 v5, v[80:83] offset:0
  ds_write_b128 v5, v[84:87] offset:1024
  ds_write_b128 v5, v[88:91] offset:2048
  ds_write_b128 v5, v[92:95] offset:3072
  s_waitcnt lgkmcnt(7)
  v_and_b32 v44, 0xffff0000, v37
  v_fmac_f32 v64, v44, v254
  v_lshlrev_b32 v45, 16, v37
  v_fmac_f32 v65, v45, v254
  v_and_b32 v44, 0xffff0000, v36
  v_fmac_f32 v66, v44, v254
  v_lshlrev_b32 v45, 16, v36
  v_fmac_f32 v67, v45, v254
  s_waitcnt lgkmcnt(6)
  v_and_b32 v44, 0xffff0000, v39
  v_fmac_f32 v68, v44, v254
  v_lshlrev_b32 v45, 16, v39
  v_fmac_f32 v69, v45, v254
  v_and_b32 v44, 0xffff0000, v38
  v_fmac_f32 v70, v44, v254
  v_lshlrev_b32 v45, 16, v38
  v_fmac_f32 v71, v45, v254
  s_waitcnt lgkmcnt(5)
  v_and_b32 v44, 0xffff0000, v41
  v_fmac_f32 v72, v44, v254
  v_lshlrev_b32 v45, 16, v41
  v_fmac_f32 v73, v45, v254
  v_and_b32 v44, 0xffff0000, v40
  v_fmac_f32 v74, v44, v254
  v_lshlrev_b32 v45, 16, v40
  v_fmac_f32 v75, v45, v254
  s_waitcnt lgkmcnt(4)
  v_and_b32 v44, 0xffff0000, v43
  v_fmac_f32 v76, v44, v254
  v_lshlrev_b32 v45, 16, v43
  v_fmac_f32 v77, v45, v254
  v_and_b32 v44, 0xffff0000, v42
  v_fmac_f32 v78, v44, v254
  v_lshlrev_b32 v45, 16, v42
  v_fmac_f32 v79, v45, v254
  s_waitcnt lgkmcnt(0)
  s_barrier
  ds_read_b128 v[20:23], v14 offset:0
  ds_read_b128 v[24:27], v14 offset:1024
  ds_read_b128 v[28:31], v14 offset:2048
  ds_read_b128 v[32:35], v14 offset:3072
  s_waitcnt lgkmcnt(3)
  v_add_f32 v64, v64, v20
  v_add_f32 v65, v65, v21
  v_add_f32 v66, v66, v22
  v_add_f32 v67, v67, v23
  v_cvt_pk_bf16_f32 v48, v64, v65
  v_cvt_pk_bf16_f32 v49, v66, v67
  s_waitcnt lgkmcnt(2)
  v_add_f32 v68, v68, v24
  v_add_f32 v69, v69, v25
  v_add_f32 v70, v70, v26
  v_add_f32 v71, v71, v27
  v_cvt_pk_bf16_f32 v50, v68, v69
  v_cvt_pk_bf16_f32 v51, v70, v71
  s_waitcnt lgkmcnt(1)
  v_add_f32 v72, v72, v28
  v_add_f32 v73, v73, v29
  v_add_f32 v74, v74, v30
  v_add_f32 v75, v75, v31
  v_cvt_pk_bf16_f32 v52, v72, v73
  v_cvt_pk_bf16_f32 v53, v74, v75
  s_waitcnt lgkmcnt(0)
  v_add_f32 v76, v76, v32
  v_add_f32 v77, v77, v33
  v_add_f32 v78, v78, v34
  v_add_f32 v79, v79, v35
  v_cvt_pk_bf16_f32 v54, v76, v77
  v_cvt_pk_bf16_f32 v55, v78, v79
  s_branch fz_cdone
fz_hi:
  s_nop 7
  ds_write_b128 v5, v[64:67] offset:0
  ds_write_b128 v5, v[68:71] offset:1024
  ds_write_b128 v5, v[72:75] offset:2048
  ds_write_b128 v5, v[76:79] offset:3072
  s_waitcnt lgkmcnt(7)
  v_and_b32 v44, 0xffff0000, v37
  v_fmac_f32 v80, v44, v254
  v_lshlrev_b32 v45, 16, v37
  v_fmac_f32 v81, v45, v254
  v_and_b32 v44, 0xffff0000, v36
  v_fmac_f32 v82, v44, v254
  v_lshlrev_b32 v45, 16, v36
  v_fmac_f32 v83, v45, v254
  s_waitcnt lgkmcnt(6)
  v_and_b32 v44, 0xffff0000, v39
  v_fmac_f32 v84, v44, v254
  v_lshlrev_b32 v45, 16, v39
  v_fmac_f32 v85, v45, v254
  v_and_b32 v44, 0xffff0000, v38
  v_fmac_f32 v86, v44, v254
  v_lshlrev_b32 v45, 16, v38
  v_fmac_f32 v87, v45, v254
  s_waitcnt lgkmcnt(5)
  v_and_b32 v44, 0xffff0000, v41
  v_fmac_f32 v88, v44, v254
  v_lshlrev_b32 v45, 16, v41
  v_fmac_f32 v89, v45, v254
  v_and_b32 v44, 0xffff0000, v40
  v_fmac_f32 v90, v44, v254
  v_lshlrev_b32 v45, 16, v40
  v_fmac_f32 v91, v45, v254
  s_waitcnt lgkmcnt(4)
  v_and_b32 v44, 0xffff0000, v43
  v_fmac_f32 v92, v44, v254
  v_lshlrev_b32 v45, 16, v43
  v_fmac_f32 v93, v45, v254
  v_and_b32 v44, 0xffff0000, v42
  v_fmac_f32 v94, v44, v254
  v_lshlrev_b32 v45, 16, v42
  v_fmac_f32 v95, v45, v254
  s_waitcnt lgkmcnt(0)
  s_barrier
  ds_read_b128 v[20:23], v14 offset:0
  ds_read_b128 v[24:27], v14 offset:1024
  ds_read_b128 v[28:31], v14 offset:2048
  ds_read_b128 v[32:35], v14 offset:3072
  s_waitcnt lgkmcnt(3)
  v_add_f32 v80, v80, v20
  v_add_f32 v81, v81, v21
  v_add_f32 v82, v82, v22
  v_add_f32 v83, v83, v23
  v_cvt_pk_bf16_f32 v48, v80, v81
  v_cvt_pk_bf16_f32 v49, v82, v83
  s_waitcnt lgkmcnt(2)
  v_add_f32 v84, v84, v24
  v_add_f32 v85, v85, v25
  v_add_f32 v86, v86, v26
  v_add_f32 v87, v87, v27
  v_cvt_pk_bf16_f32 v50, v84, v85
  v_cvt_pk_bf16_f32 v51, v86, v87
  s_waitcnt lgkmcnt(1)
  v_add_f32 v88, v88, v28
  v_add_f32 v89, v89, v29
  v_add_f32 v90, v90, v30
  v_add_f32 v91, v91, v31
  v_cvt_pk_bf16_f32 v52, v88, v89
  v_cvt_pk_bf16_f32 v53, v90, v91
  s_waitcnt lgkmcnt(0)
  v_add_f32 v92, v92, v32
  v_add_f32 v93, v93, v33
  v_add_f32 v94, v94, v34
  v_add_f32 v95, v95, v35
  v_cvt_pk_bf16_f32 v54, v92, v93
  v_cvt_pk_bf16_f32 v55, v94, v95
fz_cdone:
  s_add_u32 s7, s91, 16384
  buffer_load_dwordx4 a[160:163], v244, s[40:43], s7 offen sc1
  buffer_load_dwordx4 a[164:167], v245, s[40:43], s7 offen sc1
  s_add_u32 s7, s91, 17408
  buffer_load_dwordx4 a[168:171], v244, s[40:43], s7 offen sc1
  buffer_load_dwordx4 a[172:175], v245, s[40:43], s7 offen sc1
  buffer_store_dwordx2 v[48:49], v15, s[60:63], s84 offen offset:0 sc1
  buffer_store_dwordx2 v[50:51], v15, s[60:63], s84 offen offset:512 sc1
  buffer_store_dwordx2 v[52:53], v15, s[60:63], s84 offen offset:1024 sc1
  buffer_store_dwordx2 v[54:55], v15, s[60:63], s84 offen offset:1536 sc1
  s_waitcnt lgkmcnt(0)
  s_barrier
  s_waitcnt vmcnt(15)
  v_mfma_f32_32x32x16_bf16 v[64:79], a[0:3], a[128:131], 0
  s_waitcnt vmcnt(14)
  v_mfma_f32_32x32x16_bf16 v[96:111], a[0:3], a[132:135], 0
  v_mfma_f32_32x32x16_bf16 v[80:95], a[4:7], a[128:131], 0
  s_add_u32 s7, s91, 18432
  buffer_load_dwordx4 a[128:131], v244, s[40:43], s7 offen sc1
  v_mfma_f32_32x32x16_bf16 v[112:127], a[4:7], a[132:135], 0
  buffer_load_dwordx4 a[132:135], v245, s[40:43], s7 offen sc1
  s_waitcnt vmcnt(15)
  v_mfma_f32_32x32x16_bf16 v[64:79], a[8:11], a[136:139], v[64:79]
  s_mov_b32 s48, s4
  s_mov_b32 s49, s5
  s_mov_b32 s50, 0x200000
  s_mov_b32 s51, 0x20000
  s_add_u32 s52, s30, 0xa00000
  s_addc_u32 s53, s31, 0
  s_mov_b32 s54, 0x200000
  s_mov_b32 s55, 0x20000
  s_waitcnt vmcnt(14)
  v_mfma_f32_32x32x16_bf16 v[96:111], a[8:11], a[140:143], v[96:111]
  s_add_u32 s56, s30, 0xc60000
  s_addc_u32 s57, s31, 0
  s_mov_b32 s58, 0x8000
  s_mov_b32 s59, 0x20000
  s_mov_b32 s64, s24
  s_mov_b32 s65, s25
  s_mov_b32 s66, 0x400
  s_mov_b32 s67, 0x20000
  v_mfma_f32_32x32x16_bf16 v[80:95], a[12:15], a[136:139], v[80:95]
  s_add_u32 s7, s91, 19456
  buffer_load_dwordx4 a[136:139], v244, s[40:43], s7 offen sc1
  s_mov_b32 s44, s26
  s_mov_b32 s45, s27
  s_mov_b32 s46, 0x200000
  s_mov_b32 s47, 0x20000
  v_mfma_f32_32x32x16_bf16 v[112:127], a[12:15], a[140:143], v[112:127]
  buffer_load_dwordx4 a[140:143], v245, s[40:43], s7 offen sc1
  s_waitcnt vmcnt(15)
  v_mfma_f32_32x32x16_bf16 v[64:79], a[16:19], a[144:147], v[64:79]
  v_lshrrev_b32 v10, 2, v1
  v_and_b32 v11, 3, v1
  v_lshrrev_b32 v12, 2, v10
  v_xor_b32 v12, v12, v11
  v_lshlrev_b32 v12, 4, v12
  v_lshl_add_u32 v13, v10, 10, v12
  s_lshr_b32 s36, s35, 1
  s_lshl_b32 s36, s36, 5
  s_add_u32 s36, s36, s89
  s_and_b32 s37, s35, 1
  s_lshl_b32 s37, s37, 5
  s_waitcnt vmcnt(14)
  v_mfma_f32_32x32x16_bf16 v[96:111], a[16:19], a[148:151], v[96:111]
  s_add_u32 s37, s37, s90
  s_lshl_b32 s6, s36, 10
  s_lshl_b32 s38, s37, 1
  s_add_u32 s6, s6, s38
  s_lshl_b32 s39, s35, 11
  s_add_u32 m0, s39, 98304
  s_nop 0
  buffer_load_dwordx4 v13, s[48:51], s6 offen lds
  s_add_u32 s78, s6, 16384
  s_add_u32 m0, s39, 99328
  s_nop 0
  buffer_load_dwordx4 v13, s[48:51], s78 offen lds
  s_lshl_b32 s36, s36, 4
  v_mfma_f32_32x32x16_bf16 v[80:95], a[20:23], a[144:147], v[80:95]
  s_add_u32 s7, s91, 20480
  buffer_load_dwordx4 a[144:147], v244, s[40:43], s7 offen sc1
  v_and_b32 v14, 31, v1
  v_lshlrev_b32 v15, 4, v14
  buffer_load_dwordx4 v[16:19], v15, s[56:59], s36 offen sc1
  v_lshrrev_b32 v15, 5, v1
  v_lshlrev_b32 v12, 5, v15
  buffer_load_dwordx4 v[20:23], v12, s[64:67], s38 offen
  buffer_load_dwordx4 v[24:27], v12, s[64:67], s38 offen offset:16
  v_lshrrev_b32 v12, 2, v14
  v_and_b32 v12, 3, v12
  v_lshlrev_b32 v15, 1, v15
  v_xor_b32 v15, v15, v12
  v_mfma_f32_32x32x16_bf16 v[112:127], a[20:23], a[148:151], v[112:127]
  buffer_load_dwordx4 a[148:151], v245, s[40:43], s7 offen sc1
  v_lshlrev_b32 v15, 4, v15
  v_lshl_add_u32 v15, v14, 6, v15
  v_add_u32 v15, s39, v15
  v_add_u32 v6, 98304, v15
  v_lshrrev_b32 v15, 5, v1
  v_lshlrev_b32 v15, 5, v15
  v_lshl_add_u32 v9, v14, 10, v15
  v_add_u32 v8, 114688, v244
  s_waitcnt vmcnt(20)
  v_mfma_f32_32x32x16_bf16 v[64:79], a[24:27], a[152:155], v[64:79]
  s_waitcnt vmcnt(19)
  v_mfma_f32_32x32x16_bf16 v[96:111], a[24:27], a[156:159], v[96:111]
  v_mfma_f32_32x32x16_bf16 v[80:95], a[28:31], a[152:155], v[80:95]
  s_add_u32 s7, s91, 21504
  buffer_load_dwordx4 a[152:155], v244, s[40:43], s7 offen sc1
  v_mfma_f32_32x32x16_bf16 v[112:127], a[28:31], a[156:159], v[112:127]
  buffer_load_dwordx4 a[156:159], v245, s[40:43], s7 offen sc1
  s_waitcnt vmcnt(20)
  v_mfma_f32_32x32x16_bf16 v[64:79], a[32:35], a[160:163], v[64:79]
  s_waitcnt vmcnt(19)
  v_mfma_f32_32x32x16_bf16 v[96:111], a[32:35], a[164:167], v[96:111]
  v_mfma_f32_32x32x16_bf16 v[80:95], a[36:39], a[160:163], v[80:95]
  s_add_u32 s7, s91, 22528
  buffer_load_dwordx4 a[160:163], v244, s[40:43], s7 offen sc1
  v_mfma_f32_32x32x16_bf16 v[112:127], a[36:39], a[164:167], v[112:127]
  buffer_load_dwordx4 a[164:167], v245, s[40:43], s7 offen sc1
  s_waitcnt vmcnt(20)
  v_mfma_f32_32x32x16_bf16 v[64:79], a[40:43], a[168:171], v[64:79]
  s_waitcnt vmcnt(19)
  v_mfma_f32_32x32x16_bf16 v[96:111], a[40:43], a[172:175], v[96:111]
  v_mfma_f32_32x32x16_bf16 v[80:95], a[44:47], a[168:171], v[80:95]
  s_add_u32 s7, s91, 23552
  buffer_load_dwordx4 a[168:171], v244, s[40:43], s7 offen sc1
  v_mfma_f32_32x32x16_bf16 v[112:127], a[44:47], a[172:175], v[112:127]
  buffer_load_dwordx4 a[172:175], v245, s[40:43], s7 offen sc1
  s_waitcnt vmcnt(16)
  v_mfma_f32_32x32x16_bf16 v[64:79], a[48:51], a[128:131], v[64:79]
  s_waitcnt vmcnt(15)
  v_mfma_f32_32x32x16_bf16 v[96:111], a[48:51], a[132:135], v[96:111]
  v_mfma_f32_32x32x16_bf16 v[80:95], a[52:55], a[128:131], v[80:95]
  s_add_u32 s7, s91, 24576
  buffer_load_dwordx4 a[128:131], v244, s[40:43], s7 offen sc1
  v_mfma_f32_32x32x16_bf16 v[112:127], a[52:55], a[132:135], v[112:127]
  buffer_load_dwordx4 a[132:135], v245, s[40:43], s7 offen sc1
  v_mov_b32 v10, 163832
  v_mov_b32 v11, 1
  s_mov_b64 exec, 1
  ds_add_rtn_u32 v11, v10, v11
  s_mov_b64 exec, -1
  s_waitcnt lgkmcnt(0)
  v_readfirstlane_b32 s36, v11
  s_nop 1
  s_cmp_eq_u32 s36, 3
  s_cbranch_scc0 fz_nozp
  s_lshl_b32 s36, s33, 5
  s_add_u32 s36, s36, s34
  s_lshl_b32 s36, s36, 7
  s_add_u32 s36, s36, 163840
  v_mov_b32 v252, s32
  v_mov_b32 v253, 0
  s_mov_b64 exec, 1
  buffer_store_dword v252, v253, s[96:99], s36 offen sc1
  s_mov_b64 exec, -1
fz_nozp:
  s_waitcnt vmcnt(16)
  s_nop 2
  v_mfma_f32_32x32x16_bf16 v[64:79], a[56:59], a[136:139], v[64:79]
  s_waitcnt vmcnt(15)
  v_mfma_f32_32x32x16_bf16 v[96:111], a[56:59], a[140:143], v[96:111]
  v_mfma_f32_32x32x16_bf16 v[80:95], a[60:63], a[136:139], v[80:95]
  s_add_u32 s7, s91, 25600
  buffer_load_dwordx4 a[136:139], v244, s[40:43], s7 offen sc1
  v_mfma_f32_32x32x16_bf16 v[112:127], a[60:63], a[140:143], v[112:127]
  buffer_load_dwordx4 a[140:143], v245, s[40:43], s7 offen sc1
  s_waitcnt vmcnt(14)
  v_mfma_f32_32x32x16_bf16 v[64:79], a[64:67], a[144:147], v[64:79]
  s_waitcnt vmcnt(10)
  v_mfma_f32_32x32x16_bf16 v[96:111], a[64:67], a[148:151], v[96:111]
  v_mfma_f32_32x32x16_bf16 v[80:95], a[68:71], a[144:147], v[80:95]
  s_add_u32 s7, s91, 26624
  buffer_load_dwordx4 a[144:147], v244, s[40:43], s7 offen sc1
  v_mfma_f32_32x32x16_bf16 v[112:127], a[68:71], a[148:151], v[112:127]
  buffer_load_dwordx4 a[148:151], v245, s[40:43], s7 offen sc1
  s_waitcnt vmcnt(11)
  v_mfma_f32_32x32x16_bf16 v[64:79], a[72:75], a[152:155], v[64:79]
  s_waitcnt vmcnt(10)
  v_mfma_f32_32x32x16_bf16 v[96:111], a[72:75], a[156:159], v[96:111]
  v_mfma_f32_32x32x16_bf16 v[80:95], a[76:79], a[152:155], v[80:95]
  s_add_u32 s7, s91, 27648
  buffer_load_dwordx4 a[152:155], v244, s[40:43], s7 offen sc1
  v_mfma_f32_32x32x16_bf16 v[112:127], a[76:79], a[156:159], v[112:127]
  buffer_load_dwordx4 a[156:159], v245, s[40:43], s7 offen sc1
  s_waitcnt vmcnt(11)
  v_mfma_f32_32x32x16_bf16 v[64:79], a[80:83], a[160:163], v[64:79]
  s_waitcnt vmcnt(10)
  v_mfma_f32_32x32x16_bf16 v[96:111], a[80:83], a[164:167], v[96:111]
  v_mfma_f32_32x32x16_bf16 v[80:95], a[84:87], a[160:163], v[80:95]
  s_add_u32 s7, s91, 4096
  buffer_load_dwordx4 a[160:163], v244, s[40:43], s7 offen sc1
  v_mfma_f32_32x32x16_bf16 v[112:127], a[84:87], a[164:167], v[112:127]
  buffer_load_dwordx4 a[164:167], v245, s[40:43], s7 offen sc1
  s_waitcnt vmcnt(11)
  v_mfma_f32_32x32x16_bf16 v[64:79], a[88:91], a[168:171], v[64:79]
  s_waitcnt vmcnt(10)
  v_mfma_f32_32x32x16_bf16 v[96:111], a[88:91], a[172:175], v[96:111]
  v_mfma_f32_32x32x16_bf16 v[80:95], a[92:95], a[168:171], v[80:95]
  s_add_u32 s7, s91, 5120
  buffer_load_dwordx4 a[168:171], v244, s[40:43], s7 offen sc1
  v_mfma_f32_32x32x16_bf16 v[112:127], a[92:95], a[172:175], v[112:127]
  buffer_load_dwordx4 a[172:175], v245, s[40:43], s7 offen sc1
  s_waitcnt vmcnt(11)
  v_mfma_f32_32x32x16_bf16 v[64:79], a[96:99], a[128:131], v[64:79]
  s_waitcnt vmcnt(10)
  v_mfma_f32_32x32x16_bf16 v[96:111], a[96:99], a[132:135], v[96:111]
  v_mfma_f32_32x32x16_bf16 v[80:95], a[100:103], a[128:131], v[80:95]
  s_add_u32 s7, s91, 6144
  buffer_load_dwordx4 a[128:131], v244, s[40:43], s7 offen sc1
  v_mfma_f32_32x32x16_bf16 v[112:127], a[100:103], a[132:135], v[112:127]
  buffer_load_dwordx4 a[132:135], v245, s[40:43], s7 offen sc1
  s_waitcnt vmcnt(11)
  v_mfma_f32_32x32x16_bf16 v[64:79], a[104:107], a[136:139], v[64:79]
  s_waitcnt vmcnt(10)
  v_mfma_f32_32x32x16_bf16 v[96:111], a[104:107], a[140:143], v[96:111]
  v_mfma_f32_32x32x16_bf16 v[80:95], a[108:111], a[136:139], v[80:95]
  s_add_u32 s7, s91, 7168
  buffer_load_dwordx4 a[136:139], v244, s[40:43], s7 offen sc1
  v_mfma_f32_32x32x16_bf16 v[112:127], a[108:111], a[140:143], v[112:127]
  buffer_load_dwordx4 a[140:143], v245, s[40:43], s7 offen sc1
  s_waitcnt vmcnt(11)
  v_mfma_f32_32x32x16_bf16 v[64:79], a[112:115], a[144:147], v[64:79]
  s_waitcnt vmcnt(10)
  v_mfma_f32_32x32x16_bf16 v[96:111], a[112:115], a[148:151], v[96:111]
  v_mfma_f32_32x32x16_bf16 v[80:95], a[116:119], a[144:147], v[80:95]
  s_add_u32 s7, s91, 8192
  buffer_load_dwordx4 a[144:147], v244, s[40:43], s7 offen sc1
  v_mfma_f32_32x32x16_bf16 v[112:127], a[116:119], a[148:151], v[112:127]
  buffer_load_dwordx4 a[148:151], v245, s[40:43], s7 offen sc1
  ds_read_b64_tr_b16 v[32:33], v60 offset:32768
  ds_read_b64_tr_b16 v[34:35], v60 offset:33792
  ds_read_b64_tr_b16 v[36:37], v61 offset:32768
  ds_read_b64_tr_b16 v[38:39], v61 offset:33792
  s_waitcnt vmcnt(11)
  v_mfma_f32_32x32x16_bf16 v[64:79], a[120:123], a[152:155], v[64:79]
  s_waitcnt vmcnt(10)
  v_mfma_f32_32x32x16_bf16 v[96:111], a[120:123], a[156:159], v[96:111]
  v_mfma_f32_32x32x16_bf16 v[80:95], a[124:127], a[152:155], v[80:95]
  s_add_u32 s7, s91, 9216
  buffer_load_dwordx4 a[152:155], v244, s[40:43], s7 offen sc1
  v_mfma_f32_32x32x16_bf16 v[112:127], a[124:127], a[156:159], v[112:127]
  buffer_load_dwordx4 a[156:159], v245, s[40:43], s7 offen sc1
  ds_read_b64_tr_b16 v[40:41], v60 offset:40960
  ds_read_b64_tr_b16 v[42:43], v60 offset:41984
  ds_read_b64_tr_b16 v[44:45], v61 offset:40960
  ds_read_b64_tr_b16 v[46:47], v61 offset:41984
  s_waitcnt vmcnt(11) lgkmcnt(6)
  v_mfma_f32_32x32x16_bf16 v[64:79], v[32:35], a[160:163], v[64:79]
  s_waitcnt vmcnt(10)
  v_mfma_f32_32x32x16_bf16 v[96:111], v[32:35], a[164:167], v[96:111]
  s_waitcnt lgkmcnt(4)
  v_mfma_f32_32x32x16_bf16 v[80:95], v[36:39], a[160:163], v[80:95]
  s_add_u32 s7, s91, 10240
  buffer_load_dwordx4 a[160:163], v244, s[40:43], s7 offen sc1
  v_mfma_f32_32x32x16_bf16 v[112:127], v[36:39], a[164:167], v[112:127]
  buffer_load_dwordx4 a[164:167], v245, s[40:43], s7 offen sc1
  ds_read_b64_tr_b16 v[32:33], v60 offset:49152
  ds_read_b64_tr_b16 v[34:35], v60 offset:50176
  ds_read_b64_tr_b16 v[36:37], v61 offset:49152
  ds_read_b64_tr_b16 v[38:39], v61 offset:50176
  s_waitcnt vmcnt(11) lgkmcnt(6)
  v_mfma_f32_32x32x16_bf16 v[64:79], v[40:43], a[168:171], v[64:79]
  v_min_u32 v58, 15, v1
  v_lshlrev_b32 v58, 7, v58
  s_lshr_b32 s84, s90, 6
  s_waitcnt vmcnt(10)
  v_mfma_f32_32x32x16_bf16 v[96:111], v[40:43], a[172:175], v[96:111]
  s_lshl_b32 s84, s84, 1
  s_and_b32 s83, s35, 1
  s_add_u32 s84, s84, s83
  s_waitcnt lgkmcnt(4)
  v_mfma_f32_32x32x16_bf16 v[80:95], v[44:47], a[168:171], v[80:95]
  s_add_u32 s7, s91, 11264
  buffer_load_dwordx4 a[168:171], v244, s[40:43], s7 offen sc1
  s_lshl_b32 s84, s84, 11
  s_add_u32 s84, s84, 163840
  buffer_load_dword v56, v58, s[96:99], s84 offen sc1
  v_mfma_f32_32x32x16_bf16 v[112:127], v[44:47], a[172:175], v[112:127]
  buffer_load_dwordx4 a[172:175], v245, s[40:43], s7 offen sc1
  ds_read_b64_tr_b16 v[40:41], v60 offset:57344
  ds_read_b64_tr_b16 v[42:43], v60 offset:58368
  ds_read_b64_tr_b16 v[44:45], v61 offset:57344
  ds_read_b64_tr_b16 v[46:47], v61 offset:58368
  s_waitcnt vmcnt(12) lgkmcnt(6)
  v_mfma_f32_32x32x16_bf16 v[64:79], v[32:35], a[128:131], v[64:79]
  s_waitcnt vmcnt(11)
  v_mfma_f32_32x32x16_bf16 v[96:111], v[32:35], a[132:135], v[96:111]
  s_waitcnt lgkmcnt(4)
  v_mfma_f32_32x32x16_bf16 v[80:95], v[36:39], a[128:131], v[80:95]
  s_add_u32 s7, s91, 0
  buffer_load_dwordx4 a[128:131], v244, s[40:43], s7 offen sc1
  v_mfma_f32_32x32x16_bf16 v[112:127], v[36:39], a[132:135], v[112:127]
  buffer_load_dwordx4 a[132:135], v245, s[40:43], s7 offen sc1
  ds_read_b64_tr_b16 v[32:33], v62 offset:0
  ds_read_b64_tr_b16 v[34:35], v62 offset:1024
  ds_read_b64_tr_b16 v[36:37], v63 offset:0
  ds_read_b64_tr_b16 v[38:39], v63 offset:1024
  s_waitcnt vmcnt(12) lgkmcnt(6)
  v_mfma_f32_32x32x16_bf16 v[64:79], v[40:43], a[136:139], v[64:79]
  s_waitcnt vmcnt(11)
  v_mfma_f32_32x32x16_bf16 v[96:111], v[40:43], a[140:143], v[96:111]
  s_waitcnt lgkmcnt(4)
  v_mfma_f32_32x32x16_bf16 v[80:95], v[44:47], a[136:139], v[80:95]
  s_add_u32 s7, s91, 1024
  buffer_load_dwordx4 a[136:139], v244, s[40:43], s7 offen sc1
  v_mfma_f32_32x32x16_bf16 v[112:127], v[44:47], a[140:143], v[112:127]
  buffer_load_dwordx4 a[140:143], v245, s[40:43], s7 offen sc1
  ds_read_b64_tr_b16 v[40:41], v62 offset:8192
  ds_read_b64_tr_b16 v[42:43], v62 offset:9216
  ds_read_b64_tr_b16 v[44:45], v63 offset:8192
  ds_read_b64_tr_b16 v[46:47], v63 offset:9216
  s_waitcnt vmcnt(12) lgkmcnt(6)
  v_mfma_f32_32x32x16_bf16 v[64:79], v[32:35], a[144:147], v[64:79]
  s_waitcnt vmcnt(11)
  v_mfma_f32_32x32x16_bf16 v[96:111], v[32:35], a[148:151], v[96:111]
  s_waitcnt lgkmcnt(4)
  v_mfma_f32_32x32x16_bf16 v[80:95], v[36:39], a[144:147], v[80:95]
  s_add_u32 s7, s91, 2048
  buffer_load_dwordx4 a[144:147], v244, s[40:43], s7 offen sc1
  v_mfma_f32_32x32x16_bf16 v[112:127], v[36:39], a[148:151], v[112:127]
  buffer_load_dwordx4 a[148:151], v245, s[40:43], s7 offen sc1
  s_waitcnt vmcnt(7)
  v_cmp_ne_u32 vcc, s32, v56
  s_nop 4
  s_cbranch_vccnz fz_zlate
  ds_read_b64_tr_b16 v[32:33], v62 offset:16384
  ds_read_b64_tr_b16 v[34:35], v62 offset:17408
  ds_read_b64_tr_b16 v[36:37], v63 offset:16384
  ds_read_b64_tr_b16 v[38:39], v63 offset:17408
  s_waitcnt lgkmcnt(6)
  v_mfma_f32_32x32x16_bf16 v[64:79], v[40:43], a[152:155], v[64:79]
  v_lshrrev_b32 v10, 2, v1
  v_and_b32 v11, 3, v1
  v_lshlrev_b32 v12, 4, v11
  v_lshl_add_u32 v12, v10, 12, v12
  s_and_b32 s37, s35, 1
  s_lshl_b32 s37, s37, 5
  s_add_u32 s37, s37, s90
  s_lshl_b32 s36, s37, 12
  s_lshr_b32 s37, s35, 1
  s_lshl_b32 s37, s37, 5
  s_add_u32 s37, s37, s89
  v_mfma_f32_32x32x16_bf16 v[96:111], v[40:43], a[156:159], v[96:111]
  s_lshl_b32 s37, s37, 1
  s_add_u32 s36, s36, s37
  buffer_load_dwordx4 v[128:131], v12, s[52:55], s36 offen sc1
  s_add_u32 s36, s36, 65536
  buffer_load_dwordx4 v[132:135], v12, s[52:55], s36 offen sc1
  v_lshrrev_b32 v12, 1, v10
  v_and_b32 v12, 3, v12
  v_xor_b32 v12, v12, v11
  v_lshlrev_b32 v12, 4, v12
  v_lshl_add_u32 v12, v10, 6, v12
  s_lshl_b32 s39, s35, 11
  s_waitcnt lgkmcnt(4)
  v_mfma_f32_32x32x16_bf16 v[80:95], v[44:47], a[152:155], v[80:95]
  s_add_u32 s7, s91, 3072
  buffer_load_dwordx4 a[152:155], v244, s[40:43], s7 offen sc1
  s_add_u32 s39, s39, 106496
  v_add_u32 v11, s39, v12
  v_and_b32 v10, 15, v1
  v_lshrrev_b32 v12, 4, v1
  v_lshrrev_b32 v13, 1, v12
  v_and_b32 v12, 1, v12
  v_lshrrev_b32 v14, 2, v10
  v_lshl_add_u32 v13, v13, 4, v14
  v_and_b32 v15, 3, v10
  v_lshrrev_b32 v15, 1, v15
  v_lshl_add_u32 v15, v12, 1, v15
  v_mfma_f32_32x32x16_bf16 v[112:127], v[44:47], a[156:159], v[112:127]
  buffer_load_dwordx4 a[156:159], v245, s[40:43], s7 offen sc1
  v_lshrrev_b32 v14, 1, v14
  v_xor_b32 v15, v15, v14
  v_lshlrev_b32 v15, 4, v15
  v_lshl_add_u32 v15, v13, 6, v15
  v_and_b32 v14, 1, v10
  v_lshl_add_u32 v15, v14, 3, v15
  v_add_u32 v7, s39, v15
  v_xor_b32 v5, 32, v7
  ds_read_b64_tr_b16 v[40:41], v62 offset:24576
  ds_read_b64_tr_b16 v[42:43], v62 offset:25600
  ds_read_b64_tr_b16 v[44:45], v63 offset:24576
  ds_read_b64_tr_b16 v[46:47], v63 offset:25600
  s_waitcnt lgkmcnt(6)
  v_mfma_f32_32x32x16_bf16 v[64:79], v[32:35], a[160:163], v[64:79]
  v_mfma_f32_32x32x16_bf16 v[96:111], v[32:35], a[164:167], v[96:111]
  s_waitcnt lgkmcnt(4)
  v_mfma_f32_32x32x16_bf16 v[80:95], v[36:39], a[160:163], v[80:95]
  v_mfma_f32_32x32x16_bf16 v[112:127], v[36:39], a[164:167], v[112:127]
  ds_read_b64_tr_b16 v[32:33], v60 offset:0
  ds_read_b64_tr_b16 v[34:35], v60 offset:1024
  ds_read_b64_tr_b16 v[36:37], v61 offset:0
  ds_read_b64_tr_b16 v[38:39], v61 offset:1024
  s_waitcnt lgkmcnt(6)
  v_mfma_f32_32x32x16_bf16 v[64:79], v[40:43], a[168:171], v[64:79]
  s_waitcnt vmcnt(10)
  v_mfma_f32_32x32x16_bf16 v[96:111], v[40:43], a[172:175], v[96:111]
  s_waitcnt lgkmcnt(4)
  v_mfma_f32_32x32x16_bf16 v[80:95], v[44:47], a[168:171], v[80:95]
  v_mfma_f32_32x32x16_bf16 v[112:127], v[44:47], a[172:175], v[112:127]
  ds_read_b64_tr_b16 v[40:41], v60 offset:8192
  ds_read_b64_tr_b16 v[42:43], v60 offset:9216
  ds_read_b64_tr_b16 v[44:45], v61 offset:8192
  ds_read_b64_tr_b16 v[46:47], v61 offset:9216
  s_waitcnt vmcnt(9) lgkmcnt(6)
  v_mfma_f32_32x32x16_bf16 v[64:79], v[32:35], a[128:131], v[64:79]
  s_waitcnt vmcnt(8)
  v_mfma_f32_32x32x16_bf16 v[96:111], v[32:35], a[132:135], v[96:111]
  s_waitcnt lgkmcnt(4)
  v_mfma_f32_32x32x16_bf16 v[80:95], v[36:39], a[128:131], v[80:95]
  v_mfma_f32_32x32x16_bf16 v[112:127], v[36:39], a[132:135], v[112:127]
  ds_read_b64_tr_b16 v[32:33], v60 offset:16384
  ds_read_b64_tr_b16 v[34:35], v60 offset:17408
  ds_read_b64_tr_b16 v[36:37], v61 offset:16384
  ds_read_b64_tr_b16 v[38:39], v61 offset:17408
  s_waitcnt vmcnt(7) lgkmcnt(6)
  v_mfma_f32_32x32x16_bf16 v[64:79], v[40:43], a[136:139], v[64:79]
  s_waitcnt vmcnt(3)
  ds_write_b128 v11, v[128:131]
  s_waitcnt vmcnt(2)
  ds_write_b128 v11, v[132:135] offset:1024
  v_xor_b32 v10, 16, v6
  ds_read_b128 v[136:139], v6
  ds_read_b128 v[140:143], v10
  ds_read_b64_tr_b16 v[164:165], v7 offset:0
  ds_read_b64_tr_b16 v[166:167], v5 offset:256
  ds_read_b64_tr_b16 v[168:169], v7 offset:512
  v_mfma_f32_32x32x16_bf16 v[96:111], v[40:43], a[140:143], v[96:111]
  ds_read_b64_tr_b16 v[170:171], v5 offset:768
  v_mul_f32 v16, v16, v18
  s_waitcnt lgkmcnt(5)
  v_lshlrev_b32 v48, 16, v136
  s_waitcnt lgkmcnt(3)
  v_lshlrev_b32 v49, 16, v164
  v_lshlrev_b32 v50, 16, v20
  v_fma_f32 v144, v48, v18, -v16
  v_add_f32 v50, v50, v48
  v_fma_f32 v144, v144, v49, v50
  v_and_b32 v51, 0xffff0000, v136
  v_mfma_f32_32x32x16_bf16 v[80:95], v[44:47], a[136:139], v[80:95]
  v_and_b32 v52, 0xffff0000, v164
  v_and_b32 v53, 0xffff0000, v20
  v_fma_f32 v145, v51, v18, -v16
  v_add_f32 v53, v53, v51
  v_fma_f32 v145, v145, v52, v53
  v_lshlrev_b32 v48, 16, v137
  v_lshlrev_b32 v49, 16, v165
  v_lshlrev_b32 v50, 16, v21
  v_fma_f32 v146, v48, v18, -v16
  v_mfma_f32_32x32x16_bf16 v[112:127], v[44:47], a[140:143], v[112:127]
  v_add_f32 v50, v50, v48
  v_fma_f32 v146, v146, v49, v50
  v_and_b32 v51, 0xffff0000, v137
  v_and_b32 v52, 0xffff0000, v165
  v_and_b32 v53, 0xffff0000, v21
  v_fma_f32 v147, v51, v18, -v16
  v_add_f32 v53, v53, v51
  v_fma_f32 v147, v147, v52, v53
  v_lshlrev_b32 v48, 16, v138
  ds_read_b64_tr_b16 v[40:41], v60 offset:24576
  ds_read_b64_tr_b16 v[42:43], v60 offset:25600
  ds_read_b64_tr_b16 v[44:45], v61 offset:24576
  ds_read_b64_tr_b16 v[46:47], v61 offset:25600
  v_mfma_f32_32x32x16_bf16 v[64:79], v[32:35], a[144:147], v[64:79]
  s_waitcnt lgkmcnt(6)
  v_lshlrev_b32 v49, 16, v166
  v_lshlrev_b32 v50, 16, v22
  v_fma_f32 v148, v48, v18, -v16
  v_add_f32 v50, v50, v48
  v_fma_f32 v148, v148, v49, v50
  v_and_b32 v51, 0xffff0000, v138
  v_and_b32 v52, 0xffff0000, v166
  v_and_b32 v53, 0xffff0000, v22
  v_fma_f32 v149, v51, v18, -v16
  v_mfma_f32_32x32x16_bf16 v[96:111], v[32:35], a[148:151], v[96:111]
  v_add_f32 v53, v53, v51
  v_fma_f32 v149, v149, v52, v53
  v_lshlrev_b32 v48, 16, v139
  v_lshlrev_b32 v49, 16, v167
  v_lshlrev_b32 v50, 16, v23
  v_fma_f32 v150, v48, v18, -v16
  v_add_f32 v50, v50, v48
  v_fma_f32 v150, v150, v49, v50
  v_and_b32 v51, 0xffff0000, v139
  v_mfma_f32_32x32x16_bf16 v[80:95], v[36:39], a[144:147], v[80:95]
  v_and_b32 v52, 0xffff0000, v167
  v_and_b32 v53, 0xffff0000, v23
  v_fma_f32 v151, v51, v18, -v16
  v_add_f32 v53, v53, v51
  v_fma_f32 v151, v151, v52, v53
  v_lshlrev_b32 v48, 16, v140
  s_waitcnt lgkmcnt(5)
  v_lshlrev_b32 v49, 16, v168
  v_lshlrev_b32 v50, 16, v24
  v_fma_f32 v152, v48, v18, -v16
  v_mfma_f32_32x32x16_bf16 v[112:127], v[36:39], a[148:151], v[112:127]
  v_add_f32 v50, v50, v48
  v_fma_f32 v152, v152, v49, v50
  v_and_b32 v51, 0xffff0000, v140
  v_and_b32 v52, 0xffff0000, v168
  v_and_b32 v53, 0xffff0000, v24
  v_fma_f32 v153, v51, v18, -v16
  v_add_f32 v53, v53, v51
  v_fma_f32 v153, v153, v52, v53
  v_lshlrev_b32 v48, 16, v141
  s_waitcnt vmcnt(1) lgkmcnt(2)
  v_mfma_f32_32x32x16_bf16 v[64:79], v[40:43], a[152:155], v[64:79]
  v_lshlrev_b32 v49, 16, v169
  v_lshlrev_b32 v50, 16, v25
  v_fma_f32 v154, v48, v18, -v16
  v_add_f32 v50, v50, v48
  v_fma_f32 v154, v154, v49, v50
  v_and_b32 v51, 0xffff0000, v141
  v_and_b32 v52, 0xffff0000, v169
  v_and_b32 v53, 0xffff0000, v25
  v_fma_f32 v155, v51, v18, -v16
  s_waitcnt vmcnt(0)
  v_mfma_f32_32x32x16_bf16 v[96:111], v[40:43], a[156:159], v[96:111]
  v_add_f32 v53, v53, v51
  v_fma_f32 v155, v155, v52, v53
  v_lshlrev_b32 v48, 16, v142
  v_lshlrev_b32 v49, 16, v170
  v_lshlrev_b32 v50, 16, v26
  v_fma_f32 v156, v48, v18, -v16
  v_add_f32 v50, v50, v48
  v_fma_f32 v156, v156, v49, v50
  v_and_b32 v51, 0xffff0000, v142
  s_waitcnt lgkmcnt(0)
  v_mfma_f32_32x32x16_bf16 v[80:95], v[44:47], a[152:155], v[80:95]
  v_and_b32 v52, 0xffff0000, v170
  v_and_b32 v53, 0xffff0000, v26
  v_fma_f32 v157, v51, v18, -v16
  v_add_f32 v53, v53, v51
  v_fma_f32 v157, v157, v52, v53
  v_lshlrev_b32 v48, 16, v143
  v_lshlrev_b32 v49, 16, v171
  v_lshlrev_b32 v50, 16, v27
  v_fma_f32 v158, v48, v18, -v16
  v_mfma_f32_32x32x16_bf16 v[112:127], v[44:47], a[156:159], v[112:127]
  v_add_f32 v50, v50, v48
  v_fma_f32 v158, v158, v49, v50
  v_and_b32 v51, 0xffff0000, v143
  v_and_b32 v52, 0xffff0000, v171
  v_and_b32 v53, 0xffff0000, v27
  v_fma_f32 v159, v51, v18, -v16
  v_add_f32 v53, v53, v51
  v_fma_f32 v159, v159, v52, v53
  s_cmp_eq_u32 s35, 0
  s_cbranch_scc0 fzf_rw1
  s_nop 7
  s_nop 3
  ds_write_b128 v8, v[80:83] offset:12288
  ds_write_b128 v8, v[84:87] offset:13312
  ds_write_b128 v8, v[88:91] offset:14336
  ds_write_b128 v8, v[92:95] offset:15360
  ds_write_b128 v8, v[96:99] offset:28672
  ds_write_b128 v8, v[100:103] offset:29696
  ds_write_b128 v8, v[104:107] offset:30720
  ds_write_b128 v8, v[108:111] offset:31744
  ds_write_b128 v8, v[112:115] offset:45056
  ds_write_b128 v8, v[116:119] offset:46080
  ds_write_b128 v8, v[120:123] offset:47104
  ds_write_b128 v8, v[124:127] offset:48128
  v_mov_b32 v176, v64
  v_mov_b32 v177, v65
  v_mov_b32 v178, v66
  v_mov_b32 v179, v67
  v_mov_b32 v180, v68
  v_mov_b32 v181, v69
  v_mov_b32 v182, v70
  v_mov_b32 v183, v71
  v_mov_b32 v184, v72
  v_mov_b32 v185, v73
  v_mov_b32 v186, v74
  v_mov_b32 v187, v75
  v_mov_b32 v188, v76
  v_mov_b32 v189, v77
  v_mov_b32 v190, v78
  v_mov_b32 v191, v79
  s_branch fzf_rwd
fzf_rw1:
  s_cmp_eq_u32 s35, 1
  s_cbranch_scc0 fzf_rw2
  s_nop 7
  s_nop 3
  ds_write_b128 v8, v[64:67] offset:0
  ds_write_b128 v8, v[68:71] offset:1024
  ds_write_b128 v8, v[72:75] offset:2048
  ds_write_b128 v8, v[76:79] offset:3072
  ds_write_b128 v8, v[112:115] offset:40960
  ds_write_b128 v8, v[116:119] offset:41984
  ds_write_b128 v8, v[120:123] offset:43008
  ds_write_b128 v8, v[124:127] offset:44032
  ds_write_b128 v8, v[96:99] offset:32768
  ds_write_b128 v8, v[100:103] offset:33792
  ds_write_b128 v8, v[104:107] offset:34816
  ds_write_b128 v8, v[108:111] offset:35840
  v_mov_b32 v176, v80
  v_mov_b32 v177, v81
  v_mov_b32 v178, v82
  v_mov_b32 v179, v83
  v_mov_b32 v180, v84
  v_mov_b32 v181, v85
  v_mov_b32 v182, v86
  v_mov_b32 v183, v87
  v_mov_b32 v184, v88
  v_mov_b32 v185, v89
  v_mov_b32 v186, v90
  v_mov_b32 v187, v91
  v_mov_b32 v188, v92
  v_mov_b32 v189, v93
  v_mov_b32 v190, v94
  v_mov_b32 v191, v95
  s_branch fzf_rwd
fzf_rw2:
  s_cmp_eq_u32 s35, 2
  s_cbranch_scc0 fzf_rw3
  s_nop 7
  s_nop 3
  ds_write_b128 v8, v[112:115] offset:36864
  ds_write_b128 v8, v[116:119] offset:37888
  ds_write_b128 v8, v[120:123] offset:38912
  ds_write_b128 v8, v[124:127] offset:39936
  ds_write_b128 v8, v[64:67] offset:4096
  ds_write_b128 v8, v[68:71] offset:5120
  ds_write_b128 v8, v[72:75] offset:6144
  ds_write_b128 v8, v[76:79] offset:7168
  ds_write_b128 v8, v[80:83] offset:20480
  ds_write_b128 v8, v[84:87] offset:21504
  ds_write_b128 v8, v[88:91] offset:22528
  ds_write_b128 v8, v[92:95] offset:23552
  v_mov_b32 v176, v96
  v_mov_b32 v177, v97
  v_mov_b32 v178, v98
  v_mov_b32 v179, v99
  v_mov_b32 v180, v100
  v_mov_b32 v181, v101
  v_mov_b32 v182, v102
  v_mov_b32 v183, v103
  v_mov_b32 v184, v104
  v_mov_b32 v185, v105
  v_mov_b32 v186, v106
  v_mov_b32 v187, v107
  v_mov_b32 v188, v108
  v_mov_b32 v189, v109
  v_mov_b32 v190, v110
  v_mov_b32 v191, v111
  s_branch fzf_rwd
fzf_rw3:
  s_nop 7
  s_nop 3
  ds_write_b128 v8, v[96:99] offset:24576
  ds_write_b128 v8, v[100:103] offset:25600
  ds_write_b128 v8, v[104:107] offset:26624
  ds_write_b128 v8, v[108:111] offset:27648
  ds_write_b128 v8, v[80:83] offset:16384
  ds_write_b128 v8, v[84:87] offset:17408
  ds_write_b128 v8, v[88:91] offset:18432
  ds_write_b128 v8, v[92:95] offset:19456
  ds_write_b128 v8, v[64:67] offset:8192
  ds_write_b128 v8, v[68:71] offset:9216
  ds_write_b128 v8, v[72:75] offset:10240
  ds_write_b128 v8, v[76:79] offset:11264
  v_mov_b32 v176, v112
  v_mov_b32 v177, v113
  v_mov_b32 v178, v114
  v_mov_b32 v179, v115
  v_mov_b32 v180, v116
  v_mov_b32 v181, v117
  v_mov_b32 v182, v118
  v_mov_b32 v183, v119
  v_mov_b32 v184, v120
  v_mov_b32 v185, v121
  v_mov_b32 v186, v122
  v_mov_b32 v187, v123
  v_mov_b32 v188, v124
  v_mov_b32 v189, v125
  v_mov_b32 v190, v126
  v_mov_b32 v191, v127
fzf_rwd:
  s_mul_i32 s36, s35, 12288
  v_add_u32 v10, s36, v8
  s_waitcnt lgkmcnt(0)
  s_barrier
  ds_read_b128 v[64:67], v10 offset:0
  ds_read_b128 v[68:71], v10 offset:1024
  ds_read_b128 v[72:75], v10 offset:2048
  ds_read_b128 v[76:79], v10 offset:3072
  ds_read_b128 v[80:83], v10 offset:4096
  ds_read_b128 v[84:87], v10 offset:5120
  ds_read_b128 v[88:91], v10 offset:6144
  ds_read_b128 v[92:95], v10 offset:7168
  ds_read_b128 v[96:99], v10 offset:8192
  ds_read_b128 v[100:103], v10 offset:9216
  ds_read_b128 v[104:107], v10 offset:10240
  ds_read_b128 v[108:111], v10 offset:11264
  s_waitcnt lgkmcnt(11)
  v_add_f32 v176, v176, v64
  s_waitcnt lgkmcnt(3)
  v_add_f32 v80, v80, v96
  v_add_f32 v177, v177, v65
  v_add_f32 v81, v81, v97
  v_add_f32 v178, v178, v66
  v_add_f32 v82, v82, v98
  v_add_f32 v179, v179, v67
  v_add_f32 v83, v83, v99
  v_add_f32 v180, v180, v68
  s_waitcnt lgkmcnt(2)
  v_add_f32 v84, v84, v100
  v_add_f32 v181, v181, v69
  v_add_f32 v85, v85, v101
  v_add_f32 v182, v182, v70
  v_add_f32 v86, v86, v102
  v_add_f32 v183, v183, v71
  v_add_f32 v87, v87, v103
  v_add_f32 v184, v184, v72
  s_waitcnt lgkmcnt(1)
  v_add_f32 v88, v88, v104
  v_add_f32 v185, v185, v73
  v_add_f32 v89, v89, v105
  v_add_f32 v186, v186, v74
  v_add_f32 v90, v90, v106
  v_add_f32 v187, v187, v75
  v_add_f32 v91, v91, v107
  v_add_f32 v188, v188, v76
  s_waitcnt lgkmcnt(0)
  v_add_f32 v92, v92, v108
  v_add_f32 v189, v189, v77
  v_add_f32 v93, v93, v109
  v_add_f32 v190, v190, v78
  v_add_f32 v94, v94, v110
  v_add_f32 v191, v191, v79
  v_add_f32 v95, v95, v111
  v_add_f32 v176, v176, v80
  v_add_f32 v177, v177, v81
  v_add_f32 v178, v178, v82
  v_add_f32 v179, v179, v83
  v_add_f32 v180, v180, v84
  v_add_f32 v181, v181, v85
  v_add_f32 v182, v182, v86
  v_add_f32 v183, v183, v87
  v_add_f32 v184, v184, v88
  v_add_f32 v185, v185, v89
  v_add_f32 v186, v186, v90
  v_add_f32 v187, v187, v91
  v_add_f32 v188, v188, v92
  v_add_f32 v189, v189, v93
  v_add_f32 v190, v190, v94
  v_add_f32 v191, v191, v95
  v_add_f32 v144, v144, v176
  v_add_f32 v145, v145, v177
  v_add_f32 v146, v146, v178
  v_add_f32 v147, v147, v179
  v_add_f32 v148, v148, v180
  v_add_f32 v149, v149, v181
  v_add_f32 v150, v150, v182
  v_add_f32 v151, v151, v183
  v_add_f32 v152, v152, v184
  v_add_f32 v153, v153, v185
  v_add_f32 v154, v154, v186
  v_add_f32 v155, v155, v187
  v_add_f32 v156, v156, v188
  v_add_f32 v157, v157, v189
  v_add_f32 v158, v158, v190
  v_add_f32 v159, v159, v191
  v_cvt_pk_bf16_f32 v160, v144, v145
  v_cvt_pk_bf16_f32 v161, v146, v147
  v_cvt_pk_bf16_f32 v162, v148, v149
  v_cvt_pk_bf16_f32 v163, v150, v151
  buffer_store_dwordx4 v[160:163], v9, s[44:47], s6 offen
  v_cvt_pk_bf16_f32 v164, v152, v153
  v_cvt_pk_bf16_f32 v165, v154, v155
  v_cvt_pk_bf16_f32 v166, v156, v157
  v_cvt_pk_bf16_f32 v167, v158, v159
  buffer_store_dwordx4 v[164:167], v9, s[44:47], s6 offen offset:16
  s_branch fz_fin
fz_zlate:
  ds_read_b64_tr_b16 v[32:33], v62 offset:16384
  ds_read_b64_tr_b16 v[34:35], v62 offset:17408
  ds_read_b64_tr_b16 v[36:37], v63 offset:16384
  ds_read_b64_tr_b16 v[38:39], v63 offset:17408
  s_waitcnt lgkmcnt(6)
  v_mfma_f32_32x32x16_bf16 v[64:79], v[40:43], a[152:155], v[64:79]
  v_mfma_f32_32x32x16_bf16 v[96:111], v[40:43], a[156:159], v[96:111]
  s_waitcnt lgkmcnt(4)
  v_mfma_f32_32x32x16_bf16 v[80:95], v[44:47], a[152:155], v[80:95]
  s_add_u32 s7, s91, 3072
  buffer_load_dwordx4 a[152:155], v244, s[40:43], s7 offen sc1
  v_mfma_f32_32x32x16_bf16 v[112:127], v[44:47], a[156:159], v[112:127]
  buffer_load_dwordx4 a[156:159], v245, s[40:43], s7 offen sc1
  ds_read_b64_tr_b16 v[40:41], v62 offset:24576
  ds_read_b64_tr_b16 v[42:43], v62 offset:25600
  ds_read_b64_tr_b16 v[44:45], v63 offset:24576
  ds_read_b64_tr_b16 v[46:47], v63 offset:25600
  s_waitcnt lgkmcnt(6)
  v_mfma_f32_32x32x16_bf16 v[64:79], v[32:35], a[160:163], v[64:79]
  v_mfma_f32_32x32x16_bf16 v[96:111], v[32:35], a[164:167], v[96:111]
  s_waitcnt lgkmcnt(4)
  v_mfma_f32_32x32x16_bf16 v[80:95], v[36:39], a[160:163], v[80:95]
  v_mfma_f32_32x32x16_bf16 v[112:127], v[36:39], a[164:167], v[112:127]
  ds_read_b64_tr_b16 v[32:33], v60 offset:0
  ds_read_b64_tr_b16 v[34:35], v60 offset:1024
  ds_read_b64_tr_b16 v[36:37], v61 offset:0
  ds_read_b64_tr_b16 v[38:39], v61 offset:1024
  s_waitcnt lgkmcnt(6)
  v_mfma_f32_32x32x16_bf16 v[64:79], v[40:43], a[168:171], v[64:79]
  s_waitcnt vmcnt(8)
  v_mfma_f32_32x32x16_bf16 v[96:111], v[40:43], a[172:175], v[96:111]
  s_waitcnt lgkmcnt(4)
  v_mfma_f32_32x32x16_bf16 v[80:95], v[44:47], a[168:171], v[80:95]
  v_mfma_f32_32x32x16_bf16 v[112:127], v[44:47], a[172:175], v[112:127]
  ds_read_b64_tr_b16 v[40:41], v60 offset:8192
  ds_read_b64_tr_b16 v[42:43], v60 offset:9216
  ds_read_b64_tr_b16 v[44:45], v61 offset:8192
  ds_read_b64_tr_b16 v[46:47], v61 offset:9216
  s_waitcnt vmcnt(7) lgkmcnt(6)
  v_mfma_f32_32x32x16_bf16 v[64:79], v[32:35], a[128:131], v[64:79]
  s_waitcnt vmcnt(6)
  v_mfma_f32_32x32x16_bf16 v[96:111], v[32:35], a[132:135], v[96:111]
  s_waitcnt lgkmcnt(4)
  v_mfma_f32_32x32x16_bf16 v[80:95], v[36:39], a[128:131], v[80:95]
  v_mfma_f32_32x32x16_bf16 v[112:127], v[36:39], a[132:135], v[112:127]
  ds_read_b64_tr_b16 v[32:33], v60 offset:16384
  ds_read_b64_tr_b16 v[34:35], v60 offset:17408
  ds_read_b64_tr_b16 v[36:37], v61 offset:16384
  ds_read_b64_tr_b16 v[38:39], v61 offset:17408
  s_waitcnt vmcnt(5) lgkmcnt(6)
  v_mfma_f32_32x32x16_bf16 v[64:79], v[40:43], a[136:139], v[64:79]
  s_waitcnt vmcnt(4)
  v_mfma_f32_32x32x16_bf16 v[96:111], v[40:43], a[140:143], v[96:111]
  s_waitcnt lgkmcnt(4)
  v_mfma_f32_32x32x16_bf16 v[80:95], v[44:47], a[136:139], v[80:95]
  v_mfma_f32_32x32x16_bf16 v[112:127], v[44:47], a[140:143], v[112:127]
  ds_read_b64_tr_b16 v[40:41], v60 offset:24576
  ds_read_b64_tr_b16 v[42:43], v60 offset:25600
  ds_read_b64_tr_b16 v[44:45], v61 offset:24576
  ds_read_b64_tr_b16 v[46:47], v61 offset:25600
  s_waitcnt vmcnt(3) lgkmcnt(6)
  v_mfma_f32_32x32x16_bf16 v[64:79], v[32:35], a[144:147], v[64:79]
  s_waitcnt vmcnt(2)
  v_mfma_f32_32x32x16_bf16 v[96:111], v[32:35], a[148:151], v[96:111]
  s_waitcnt lgkmcnt(4)
  v_mfma_f32_32x32x16_bf16 v[80:95], v[36:39], a[144:147], v[80:95]
  v_mfma_f32_32x32x16_bf16 v[112:127], v[36:39], a[148:151], v[112:127]
  s_waitcnt vmcnt(1) lgkmcnt(2)
  v_mfma_f32_32x32x16_bf16 v[64:79], v[40:43], a[152:155], v[64:79]
  s_waitcnt vmcnt(0)
  v_mfma_f32_32x32x16_bf16 v[96:111], v[40:43], a[156:159], v[96:111]
  s_waitcnt lgkmcnt(0)
  v_mfma_f32_32x32x16_bf16 v[80:95], v[44:47], a[152:155], v[80:95]
  v_mfma_f32_32x32x16_bf16 v[112:127], v[44:47], a[156:159], v[112:127]
  s_cmp_eq_u32 s35, 0
  s_cbranch_scc0 fzs_rw1
  s_nop 7
  s_nop 3
  ds_write_b128 v8, v[80:83] offset:12288
  ds_write_b128 v8, v[84:87] offset:13312
  ds_write_b128 v8, v[88:91] offset:14336
  ds_write_b128 v8, v[92:95] offset:15360
  ds_write_b128 v8, v[96:99] offset:28672
  ds_write_b128 v8, v[100:103] offset:29696
  ds_write_b128 v8, v[104:107] offset:30720
  ds_write_b128 v8, v[108:111] offset:31744
  ds_write_b128 v8, v[112:115] offset:45056
  ds_write_b128 v8, v[116:119] offset:46080
  ds_write_b128 v8, v[120:123] offset:47104
  ds_write_b128 v8, v[124:127] offset:48128
  v_mov_b32 v176, v64
  v_mov_b32 v177, v65
  v_mov_b32 v178, v66
  v_mov_b32 v179, v67
  v_mov_b32 v180, v68
  v_mov_b32 v181, v69
  v_mov_b32 v182, v70
  v_mov_b32 v183, v71
  v_mov_b32 v184, v72
  v_mov_b32 v185, v73
  v_mov_b32 v186, v74
  v_mov_b32 v187, v75
  v_mov_b32 v188, v76
  v_mov_b32 v189, v77
  v_mov_b32 v190, v78
  v_mov_b32 v191, v79
  s_branch fzs_rwd
fzs_rw1:
  s_cmp_eq_u32 s35, 1
  s_cbranch_scc0 fzs_rw2
  s_nop 7
  s_nop 3
  ds_write_b128 v8, v[64:67] offset:0
  ds_write_b128 v8, v[68:71] offset:1024
  ds_write_b128 v8, v[72:75] offset:2048
  ds_write_b128 v8, v[76:79] offset:3072
  ds_write_b128 v8, v[112:115] offset:40960
  ds_write_b128 v8, v[116:119] offset:41984
  ds_write_b128 v8, v[120:123] offset:43008
  ds_write_b128 v8, v[124:127] offset:44032
  ds_write_b128 v8, v[96:99] offset:32768
  ds_write_b128 v8, v[100:103] offset:33792
  ds_write_b128 v8, v[104:107] offset:34816
  ds_write_b128 v8, v[108:111] offset:35840
  v_mov_b32 v176, v80
  v_mov_b32 v177, v81
  v_mov_b32 v178, v82
  v_mov_b32 v179, v83
  v_mov_b32 v180, v84
  v_mov_b32 v181, v85
  v_mov_b32 v182, v86
  v_mov_b32 v183, v87
  v_mov_b32 v184, v88
  v_mov_b32 v185, v89
  v_mov_b32 v186, v90
  v_mov_b32 v187, v91
  v_mov_b32 v188, v92
  v_mov_b32 v189, v93
  v_mov_b32 v190, v94
  v_mov_b32 v191, v95
  s_branch fzs_rwd
fzs_rw2:
  s_cmp_eq_u32 s35, 2
  s_cbranch_scc0 fzs_rw3
  s_nop 7
  s_nop 3
  ds_write_b128 v8, v[112:115] offset:36864
  ds_write_b128 v8, v[116:119] offset:37888
  ds_write_b128 v8, v[120:123] offset:38912
  ds_write_b128 v8, v[124:127] offset:39936
  ds_write_b128 v8, v[64:67] offset:4096
  ds_write_b128 v8, v[68:71] offset:5120
  ds_write_b128 v8, v[72:75] offset:6144
  ds_write_b128 v8, v[76:79] offset:7168
  ds_write_b128 v8, v[80:83] offset:20480
  ds_write_b128 v8, v[84:87] offset:21504
  ds_write_b128 v8, v[88:91] offset:22528
  ds_write_b128 v8, v[92:95] offset:23552
  v_mov_b32 v176, v96
  v_mov_b32 v177, v97
  v_mov_b32 v178, v98
  v_mov_b32 v179, v99
  v_mov_b32 v180, v100
  v_mov_b32 v181, v101
  v_mov_b32 v182, v102
  v_mov_b32 v183, v103
  v_mov_b32 v184, v104
  v_mov_b32 v185, v105
  v_mov_b32 v186, v106
  v_mov_b32 v187, v107
  v_mov_b32 v188, v108
  v_mov_b32 v189, v109
  v_mov_b32 v190, v110
  v_mov_b32 v191, v111
  s_branch fzs_rwd
fzs_rw3:
  s_nop 7
  s_nop 3
  ds_write_b128 v8, v[96:99] offset:24576
  ds_write_b128 v8, v[100:103] offset:25600
  ds_write_b128 v8, v[104:107] offset:26624
  ds_write_b128 v8, v[108:111] offset:27648
  ds_write_b128 v8, v[80:83] offset:16384
  ds_write_b128 v8, v[84:87] offset:17408
  ds_write_b128 v8, v[88:91] offset:18432
  ds_write_b128 v8, v[92:95] offset:19456
  ds_write_b128 v8, v[64:67] offset:8192
  ds_write_b128 v8, v[68:71] offset:9216
  ds_write_b128 v8, v[72:75] offset:10240
  ds_write_b128 v8, v[76:79] offset:11264
  v_mov_b32 v176, v112
  v_mov_b32 v177, v113
  v_mov_b32 v178, v114
  v_mov_b32 v179, v115
  v_mov_b32 v180, v116
  v_mov_b32 v181, v117
  v_mov_b32 v182, v118
  v_mov_b32 v183, v119
  v_mov_b32 v184, v120
  v_mov_b32 v185, v121
  v_mov_b32 v186, v122
  v_mov_b32 v187, v123
  v_mov_b32 v188, v124
  v_mov_b32 v189, v125
  v_mov_b32 v190, v126
  v_mov_b32 v191, v127
fzs_rwd:
  s_mul_i32 s36, s35, 12288
  v_add_u32 v10, s36, v8
  s_waitcnt lgkmcnt(0)
  s_barrier
  ds_read_b128 v[64:67], v10 offset:0
  ds_read_b128 v[68:71], v10 offset:1024
  ds_read_b128 v[72:75], v10 offset:2048
  ds_read_b128 v[76:79], v10 offset:3072
  ds_read_b128 v[80:83], v10 offset:4096
  ds_read_b128 v[84:87], v10 offset:5120
  ds_read_b128 v[88:91], v10 offset:6144
  ds_read_b128 v[92:95], v10 offset:7168
  ds_read_b128 v[96:99], v10 offset:8192
  ds_read_b128 v[100:103], v10 offset:9216
  ds_read_b128 v[104:107], v10 offset:10240
  ds_read_b128 v[108:111], v10 offset:11264
  s_waitcnt lgkmcnt(11)
  v_add_f32 v176, v176, v64
  s_waitcnt lgkmcnt(3)
  v_add_f32 v80, v80, v96
  v_add_f32 v177, v177, v65
  v_add_f32 v81, v81, v97
  v_add_f32 v178, v178, v66
  v_add_f32 v82, v82, v98
  v_add_f32 v179, v179, v67
  v_add_f32 v83, v83, v99
  v_add_f32 v180, v180, v68
  s_waitcnt lgkmcnt(2)
  v_add_f32 v84, v84, v100
  v_add_f32 v181, v181, v69
  v_add_f32 v85, v85, v101
  v_add_f32 v182, v182, v70
  v_add_f32 v86, v86, v102
  v_add_f32 v183, v183, v71
  v_add_f32 v87, v87, v103
  v_add_f32 v184, v184, v72
  s_waitcnt lgkmcnt(1)
  v_add_f32 v88, v88, v104
  v_add_f32 v185, v185, v73
  v_add_f32 v89, v89, v105
  v_add_f32 v186, v186, v74
  v_add_f32 v90, v90, v106
  v_add_f32 v187, v187, v75
  v_add_f32 v91, v91, v107
  v_add_f32 v188, v188, v76
  s_waitcnt lgkmcnt(0)
  v_add_f32 v92, v92, v108
  v_add_f32 v189, v189, v77
  v_add_f32 v93, v93, v109
  v_add_f32 v190, v190, v78
  v_add_f32 v94, v94, v110
  v_add_f32 v191, v191, v79
  v_add_f32 v95, v95, v111
  v_add_f32 v176, v176, v80
  v_add_f32 v177, v177, v81
  v_add_f32 v178, v178, v82
  v_add_f32 v179, v179, v83
  v_add_f32 v180, v180, v84
  v_add_f32 v181, v181, v85
  v_add_f32 v182, v182, v86
  v_add_f32 v183, v183, v87
  v_add_f32 v184, v184, v88
  v_add_f32 v185, v185, v89
  v_add_f32 v186, v186, v90
  v_add_f32 v187, v187, v91
  v_add_f32 v188, v188, v92
  v_add_f32 v189, v189, v93
  v_add_f32 v190, v190, v94
  v_add_f32 v191, v191, v95
  buffer_load_dword v56, v58, s[96:99], s84 offen sc1
  s_waitcnt vmcnt(0)
  v_cmp_ne_u32 vcc, s32, v56
  s_nop 4
  s_cbranch_vccz Lp6_ok
  s_mov_b32 s79, 0
Lp6_loop:
  s_sleep 2
  buffer_load_dword v56, v58, s[96:99], s84 offen sc1
  s_waitcnt vmcnt(0)
  v_cmp_ne_u32 vcc, s32, v56
  s_nop 4
  s_cbranch_vccz Lp6_ok
  s_add_u32 s79, s79, 1
  s_cmp_lt_u32 s79, 0x40000
  s_cbranch_scc1 Lp6_loop
Lp6_ok:
  v_lshrrev_b32 v10, 2, v1
  v_and_b32 v11, 3, v1
  v_lshlrev_b32 v12, 4, v11
  v_lshl_add_u32 v12, v10, 12, v12
  s_and_b32 s37, s35, 1
  s_lshl_b32 s37, s37, 5
  s_add_u32 s37, s37, s90
  s_lshl_b32 s36, s37, 12
  s_lshr_b32 s37, s35, 1
  s_lshl_b32 s37, s37, 5
  s_add_u32 s37, s37, s89
  s_lshl_b32 s37, s37, 1
  s_add_u32 s36, s36, s37
  buffer_load_dwordx4 v[128:131], v12, s[52:55], s36 offen sc1
  s_add_u32 s36, s36, 65536
  buffer_load_dwordx4 v[132:135], v12, s[52:55], s36 offen sc1
  v_lshrrev_b32 v12, 1, v10
  v_and_b32 v12, 3, v12
  v_xor_b32 v12, v12, v11
  v_lshlrev_b32 v12, 4, v12
  v_lshl_add_u32 v12, v10, 6, v12
  s_lshl_b32 s39, s35, 11
  s_add_u32 s39, s39, 106496
  v_add_u32 v11, s39, v12
  v_and_b32 v10, 15, v1
  v_lshrrev_b32 v12, 4, v1
  v_lshrrev_b32 v13, 1, v12
  v_and_b32 v12, 1, v12
  v_lshrrev_b32 v14, 2, v10
  v_lshl_add_u32 v13, v13, 4, v14
  v_and_b32 v15, 3, v10
  v_lshrrev_b32 v15, 1, v15
  v_lshl_add_u32 v15, v12, 1, v15
  v_lshrrev_b32 v14, 1, v14
  v_xor_b32 v15, v15, v14
  v_lshlrev_b32 v15, 4, v15
  v_lshl_add_u32 v15, v13, 6, v15
  v_and_b32 v14, 1, v10
  v_lshl_add_u32 v15, v14, 3, v15
  v_add_u32 v7, s39, v15
  v_xor_b32 v5, 32, v7
  s_waitcnt vmcnt(1)
  ds_write_b128 v11, v[128:131]
  s_waitcnt vmcnt(0)
  ds_write_b128 v11, v[132:135] offset:1024
  v_xor_b32 v10, 16, v6
  ds_read_b128 v[136:139], v6
  ds_read_b128 v[140:143], v10
  ds_read_b64_tr_b16 v[164:165], v7 offset:0
  ds_read_b64_tr_b16 v[166:167], v5 offset:256
  ds_read_b64_tr_b16 v[168:169], v7 offset:512
  ds_read_b64_tr_b16 v[170:171], v5 offset:768
  v_mul_f32 v16, v16, v18
  s_waitcnt lgkmcnt(5)
  v_lshlrev_b32 v48, 16, v136
  s_waitcnt lgkmcnt(3)
  v_lshlrev_b32 v49, 16, v164
  v_lshlrev_b32 v50, 16, v20
  v_fma_f32 v144, v48, v18, -v16
  v_add_f32 v50, v50, v48
  v_fma_f32 v144, v144, v49, v50
  v_and_b32 v51, 0xffff0000, v136
  v_and_b32 v52, 0xffff0000, v164
  v_and_b32 v53, 0xffff0000, v20
  v_fma_f32 v145, v51, v18, -v16
  v_add_f32 v53, v53, v51
  v_fma_f32 v145, v145, v52, v53
  v_lshlrev_b32 v48, 16, v137
  v_lshlrev_b32 v49, 16, v165
  v_lshlrev_b32 v50, 16, v21
  v_fma_f32 v146, v48, v18, -v16
  v_add_f32 v50, v50, v48
  v_fma_f32 v146, v146, v49, v50
  v_and_b32 v51, 0xffff0000, v137
  v_and_b32 v52, 0xffff0000, v165
  v_and_b32 v53, 0xffff0000, v21
  v_fma_f32 v147, v51, v18, -v16
  v_add_f32 v53, v53, v51
  v_fma_f32 v147, v147, v52, v53
  v_lshlrev_b32 v48, 16, v138
  s_waitcnt lgkmcnt(2)
  v_lshlrev_b32 v49, 16, v166
  v_lshlrev_b32 v50, 16, v22
  v_fma_f32 v148, v48, v18, -v16
  v_add_f32 v50, v50, v48
  v_fma_f32 v148, v148, v49, v50
  v_and_b32 v51, 0xffff0000, v138
  v_and_b32 v52, 0xffff0000, v166
  v_and_b32 v53, 0xffff0000, v22
  v_fma_f32 v149, v51, v18, -v16
  v_add_f32 v53, v53, v51
  v_fma_f32 v149, v149, v52, v53
  v_lshlrev_b32 v48, 16, v139
  v_lshlrev_b32 v49, 16, v167
  v_lshlrev_b32 v50, 16, v23
  v_fma_f32 v150, v48, v18, -v16
  v_add_f32 v50, v50, v48
  v_fma_f32 v150, v150, v49, v50
  v_and_b32 v51, 0xffff0000, v139
  v_and_b32 v52, 0xffff0000, v167
  v_and_b32 v53, 0xffff0000, v23
  v_fma_f32 v151, v51, v18, -v16
  v_add_f32 v53, v53, v51
  v_fma_f32 v151, v151, v52, v53
  v_lshlrev_b32 v48, 16, v140
  s_waitcnt lgkmcnt(1)
  v_lshlrev_b32 v49, 16, v168
  v_lshlrev_b32 v50, 16, v24
  v_fma_f32 v152, v48, v18, -v16
  v_add_f32 v50, v50, v48
  v_fma_f32 v152, v152, v49, v50
  v_and_b32 v51, 0xffff0000, v140
  v_and_b32 v52, 0xffff0000, v168
  v_and_b32 v53, 0xffff0000, v24
  v_fma_f32 v153, v51, v18, -v16
  v_add_f32 v53, v53, v51
  v_fma_f32 v153, v153, v52, v53
  v_lshlrev_b32 v48, 16, v141
  v_lshlrev_b32 v49, 16, v169
  v_lshlrev_b32 v50, 16, v25
  v_fma_f32 v154, v48, v18, -v16
  v_add_f32 v50, v50, v48
  v_fma_f32 v154, v154, v49, v50
  v_and_b32 v51, 0xffff0000, v141
  v_and_b32 v52, 0xffff0000, v169
  v_and_b32 v53, 0xffff0000, v25
  v_fma_f32 v155, v51, v18, -v16
  v_add_f32 v53, v53, v51
  v_fma_f32 v155, v155, v52, v53
  v_lshlrev_b32 v48, 16, v142
  s_waitcnt lgkmcnt(0)
  v_lshlrev_b32 v49, 16, v170
  v_lshlrev_b32 v50, 16, v26
  v_fma_f32 v156, v48, v18, -v16
  v_add_f32 v50, v50, v48
  v_fma_f32 v156, v156, v49, v50
  v_and_b32 v51, 0xffff0000, v142
  v_and_b32 v52, 0xffff0000, v170
  v_and_b32 v53, 0xffff0000, v26
  v_fma_f32 v157, v51, v18, -v16
  v_add_f32 v53, v53, v51
  v_fma_f32 v157, v157, v52, v53
  v_lshlrev_b32 v48, 16, v143
  v_lshlrev_b32 v49, 16, v171
  v_lshlrev_b32 v50, 16, v27
  v_fma_f32 v158, v48, v18, -v16
  v_add_f32 v50, v50, v48
  v_fma_f32 v158, v158, v49, v50
  v_and_b32 v51, 0xffff0000, v143
  v_and_b32 v52, 0xffff0000, v171
  v_and_b32 v53, 0xffff0000, v27
  v_fma_f32 v159, v51, v18, -v16
  v_add_f32 v53, v53, v51
  v_fma_f32 v159, v159, v52, v53
  v_add_f32 v144, v144, v176
  v_add_f32 v145, v145, v177
  v_add_f32 v146, v146, v178
  v_add_f32 v147, v147, v179
  v_add_f32 v148, v148, v180
  v_add_f32 v149, v149, v181
  v_add_f32 v150, v150, v182
  v_add_f32 v151, v151, v183
  v_add_f32 v152, v152, v184
  v_add_f32 v153, v153, v185
  v_add_f32 v154, v154, v186
  v_add_f32 v155, v155, v187
  v_add_f32 v156, v156, v188
  v_add_f32 v157, v157, v189
  v_add_f32 v158, v158, v190
  v_add_f32 v159, v159, v191
  v_cvt_pk_bf16_f32 v160, v144, v145
  v_cvt_pk_bf16_f32 v161, v146, v147
  v_cvt_pk_bf16_f32 v162, v148, v149
  v_cvt_pk_bf16_f32 v163, v150, v151
  buffer_store_dwordx4 v[160:163], v9, s[44:47], s6 offen
  v_cvt_pk_bf16_f32 v164, v152, v153
  v_cvt_pk_bf16_f32 v165, v154, v155
  v_cvt_pk_bf16_f32 v166, v156, v157
  v_cvt_pk_bf16_f32 v167, v158, v159
  buffer_store_dwordx4 v[164:167], v9, s[44:47], s6 offen offset:16
  s_waitcnt vmcnt(63)
fz_fin:
  s_endpgm
fz_spare:
  s_sub_u32 s72, s34, 28
  s_lshr_b32 s36, s33, 1
  s_lshl_b32 s36, s36, 9
  s_and_b32 s37, s33, 1
  s_lshl_b32 s37, s37, 2
  s_add_u32 s37, s37, s72
  s_lshl_b32 s37, s37, 6
  s_add_u32 s36, s36, s37
  s_lshl_b32 s37, s35, 4
  s_add_u32 s73, s36, s37
  s_lshl_b32 s36, s73, 10
  v_lshrrev_b32 v10, 3, v1
  v_and_b32 v11, 7, v1
  v_lshlrev_b32 v11, 4, v11
  v_lshl_add_u32 v10, v10, 10, v11
  buffer_load_dwordx4 v[128:131], v10, s[52:55], s36 offen offset:0
  buffer_load_dwordx4 v[132:135], v10, s[52:55], s36 offen offset:128
  buffer_load_dwordx4 v[136:139], v10, s[52:55], s36 offen offset:256
  buffer_load_dwordx4 v[140:143], v10, s[52:55], s36 offen offset:384
  buffer_load_dwordx4 v[144:147], v10, s[52:55], s36 offen offset:512
  buffer_load_dwordx4 v[148:151], v10, s[52:55], s36 offen offset:640
  buffer_load_dwordx4 v[152:155], v10, s[52:55], s36 offen offset:768
  buffer_load_dwordx4 v[156:159], v10, s[52:55], s36 offen offset:896
  s_add_u32 s36, s36, 8192
  buffer_load_dwordx4 v[160:163], v10, s[52:55], s36 offen offset:0
  buffer_load_dwordx4 v[164:167], v10, s[52:55], s36 offen offset:128
  buffer_load_dwordx4 v[168:171], v10, s[52:55], s36 offen offset:256
  buffer_load_dwordx4 v[172:175], v10, s[52:55], s36 offen offset:384
  buffer_load_dwordx4 v[176:179], v10, s[52:55], s36 offen offset:512
  buffer_load_dwordx4 v[180:183], v10, s[52:55], s36 offen offset:640
  s_waitcnt vmcnt(22)
  buffer_load_dwordx4 v[184:187], v10, s[52:55], s36 offen offset:768
  buffer_load_dwordx4 v[188:191], v10, s[52:55], s36 offen offset:896
  s_lshr_b32 s74, s33, 1
  s_lshl_b32 s74, s74, 2
  s_add_u32 s74, s74, s72
  s_lshl_b32 s36, s74, 5
  s_lshl_b32 s37, s35, 3
  s_add_u32 s36, s36, s37
  s_mul_i32 s36, s36, 3584
  s_and_b32 s37, s33, 1
  s_mul_i32 s37, s37, 1792
  s_add_u32 s36, s36, s37
  v_lshlrev_b32 v12, 4, v1
  buffer_load_dwordx4 v[64:67], v12, s[56:59], s36 offen
  buffer_load_dwordx4 v[68:71], v12, s[56:59], s36 offen offset:1024
  s_add_u32 s36, s36, 3584
  buffer_load_dwordx4 v[72:75], v12, s[56:59], s36 offen
  buffer_load_dwordx4 v[76:79], v12, s[56:59], s36 offen offset:1024
  s_add_u32 s36, s36, 3584
  buffer_load_dwordx4 v[80:83], v12, s[56:59], s36 offen
  buffer_load_dwordx4 v[84:87], v12, s[56:59], s36 offen offset:1024
  s_add_u32 s36, s36, 3584
  buffer_load_dwordx4 v[88:91], v12, s[56:59], s36 offen
  buffer_load_dwordx4 v[92:95], v12, s[56:59], s36 offen offset:1024
  s_add_u32 s36, s36, 3584
  buffer_load_dwordx4 v[96:99], v12, s[56:59], s36 offen
  buffer_load_dwordx4 v[100:103], v12, s[56:59], s36 offen offset:1024
  s_add_u32 s36, s36, 3584
  buffer_load_dwordx4 v[104:107], v12, s[56:59], s36 offen
  buffer_load_dwordx4 v[108:111], v12, s[56:59], s36 offen offset:1024
  s_add_u32 s36, s36, 3584
  buffer_load_dwordx4 v[112:115], v12, s[56:59], s36 offen
  buffer_load_dwordx4 v[116:119], v12, s[56:59], s36 offen offset:1024
  s_add_u32 s36, s36, 3584
  buffer_load_dwordx4 v[120:123], v12, s[56:59], s36 offen
  buffer_load_dwordx4 v[124:127], v12, s[56:59], s36 offen offset:1024
  s_add_u32 s96, s30, 0xe00000
  s_addc_u32 s97, s31, 0
  s_mov_b32 s98, 0x48000
  s_mov_b32 s99, 0x20000
  s_add_u32 s60, s30, 0x800000
  s_addc_u32 s61, s31, 0
  s_mov_b32 s62, 0x200000
  s_mov_b32 s63, 0x20000
  s_add_u32 s64, s30, 0xc60000
  s_addc_u32 s65, s31, 0
  s_mov_b32 s66, 0x8000
  s_mov_b32 s67, 0x20000
  s_add_u32 s68, s30, 0xc10000
  s_addc_u32 s69, s31, 0
  s_mov_b32 s70, 0x38000
  s_mov_b32 s71, 0x20000
  s_lshl_b32 s36, s35, 9
  s_add_u32 s36, s36, 139264
  v_and_b32 v11, 31, v1
  v_lshlrev_b32 v11, 4, v11
  v_add_u32 v11, s36, v11
  v_lshlrev_b32 v2, 6, v3
  v_add_u32 v2, s36, v2
  s_waitcnt vmcnt(32)
  ds_write_b128 v11, v[44:47]
  s_lshl_b32 s36, s35, 3
  s_sub_u32 s36, 31, s36
  v_sub_u32 v15, s36, v4
  v_lshrrev_b32 v6, 2, v15
  v_xor_b32 v6, v6, v3
  v_and_b32 v15, 3, v15
  v_lshlrev_b32 v15, 2, v15
  v_lshl_add_u32 v15, v6, 4, v15
  v_lshl_add_u32 v15, v3, 10, v15
  v_add_u32 v15, 131072, v15
  s_waitcnt lgkmcnt(0)
  ds_read_b128 v[44:47], v2 offset:0
  ds_read_b128 v[48:51], v2 offset:16
  ds_read_b128 v[52:55], v2 offset:32
  ds_read_b128 v[56:59], v2 offset:48
  s_mov_b32 s76, 0x05040100
  s_mov_b32 s77, 0x07060302
  v_perm_b32 v200, v24, v28, s76
  v_perm_b32 v201, v16, v20, s76
  v_perm_b32 v202, v28, v32, s76
  v_perm_b32 v203, v20, v24, s76
  s_waitcnt lgkmcnt(3)
  v_dot2_f32_bf16 v204, v200, v44, 0
  v_dot2_f32_bf16 v205, v202, v44, 0
  v_lshlrev_b32 v206, 16, v36
  v_lshlrev_b32 v207, 16, v40
  v_dot2_f32_bf16 v204, v201, v45, v204
  v_dot2_f32_bf16 v205, v203, v45, v205
  v_perm_b32 v208, v24, v28, s77
  v_perm_b32 v209, v16, v20, s77
  v_perm_b32 v210, v28, v32, s77
  v_perm_b32 v211, v20, v24, s77
  v_dot2_f32_bf16 v212, v208, v46, 0
  v_dot2_f32_bf16 v213, v210, v46, 0
  v_and_b32 v214, 0xffff0000, v36
  v_and_b32 v215, 0xffff0000, v40
  v_dot2_f32_bf16 v212, v209, v47, v212
  v_dot2_f32_bf16 v213, v211, v47, v213
  v_mul_f32 v204, v204, v206
  v_mul_f32 v205, v205, v207
  v_cvt_pk_bf16_f32 v192, v205, v204
  ds_write_b32 v15, v192 offset:0
  v_perm_b32 v200, v25, v29, s76
  v_perm_b32 v201, v17, v21, s76
  v_perm_b32 v202, v29, v33, s76
  v_perm_b32 v203, v21, v25, s76
  s_waitcnt lgkmcnt(3)
  v_dot2_f32_bf16 v204, v200, v48, 0
  v_dot2_f32_bf16 v205, v202, v48, 0
  v_lshlrev_b32 v206, 16, v37
  v_lshlrev_b32 v207, 16, v41
  v_dot2_f32_bf16 v204, v201, v49, v204
  v_dot2_f32_bf16 v205, v203, v49, v205
  v_mul_f32 v212, v212, v214
  v_mul_f32 v213, v213, v215
  v_cvt_pk_bf16_f32 v193, v213, v212
  ds_write_b32 v15, v193 offset:128
  v_perm_b32 v208, v25, v29, s77
  v_perm_b32 v209, v17, v21, s77
  v_perm_b32 v210, v29, v33, s77
  v_perm_b32 v211, v21, v25, s77
  v_dot2_f32_bf16 v212, v208, v50, 0
  v_dot2_f32_bf16 v213, v210, v50, 0
  v_and_b32 v214, 0xffff0000, v37
  v_and_b32 v215, 0xffff0000, v41
  v_dot2_f32_bf16 v212, v209, v51, v212
  v_dot2_f32_bf16 v213, v211, v51, v213
  v_mul_f32 v204, v204, v206
  v_mul_f32 v205, v205, v207
  v_cvt_pk_bf16_f32 v194, v205, v204
  ds_write_b32 v15, v194 offset:256
  v_perm_b32 v200, v26, v30, s76
  v_perm_b32 v201, v18, v22, s76
  v_perm_b32 v202, v30, v34, s76
  v_perm_b32 v203, v22, v26, s76
  s_waitcnt lgkmcnt(4)
  v_dot2_f32_bf16 v204, v200, v52, 0
  v_dot2_f32_bf16 v205, v202, v52, 0
  v_lshlrev_b32 v206, 16, v38
  v_lshlrev_b32 v207, 16, v42
  v_dot2_f32_bf16 v204, v201, v53, v204
  v_dot2_f32_bf16 v205, v203, v53, v205
  v_mul_f32 v212, v212, v214
  v_mul_f32 v213, v213, v215
  v_cvt_pk_bf16_f32 v195, v213, v212
  ds_write_b32 v15, v195 offset:384
  v_perm_b32 v208, v26, v30, s77
  v_perm_b32 v209, v18, v22, s77
  v_perm_b32 v210, v30, v34, s77
  v_perm_b32 v211, v22, v26, s77
  v_dot2_f32_bf16 v212, v208, v54, 0
  v_dot2_f32_bf16 v213, v210, v54, 0
  v_and_b32 v214, 0xffff0000, v38
  v_and_b32 v215, 0xffff0000, v42
  v_dot2_f32_bf16 v212, v209, v55, v212
  v_dot2_f32_bf16 v213, v211, v55, v213
  v_mul_f32 v204, v204, v206
  v_mul_f32 v205, v205, v207
  v_cvt_pk_bf16_f32 v196, v205, v204
  ds_write_b32 v15, v196 offset:512
  v_perm_b32 v200, v27, v31, s76
  v_perm_b32 v201, v19, v23, s76
  v_perm_b32 v202, v31, v35, s76
  v_perm_b32 v203, v23, v27, s76
  s_waitcnt lgkmcnt(5)
  v_dot2_f32_bf16 v204, v200, v56, 0
  v_dot2_f32_bf16 v205, v202, v56, 0
  v_lshlrev_b32 v206, 16, v39
  v_lshlrev_b32 v207, 16, v43
  v_dot2_f32_bf16 v204, v201, v57, v204
  v_dot2_f32_bf16 v205, v203, v57, v205
  v_mul_f32 v212, v212, v214
  v_mul_f32 v213, v213, v215
  v_cvt_pk_bf16_f32 v197, v213, v212
  ds_write_b32 v15, v197 offset:640
  v_perm_b32 v208, v27, v31, s77
  v_perm_b32 v209, v19, v23, s77
  v_perm_b32 v210, v31, v35, s77
  v_perm_b32 v211, v23, v27, s77
  v_dot2_f32_bf16 v212, v208, v58, 0
  v_dot2_f32_bf16 v213, v210, v58, 0
  v_and_b32 v214, 0xffff0000, v39
  v_and_b32 v215, 0xffff0000, v43
  v_dot2_f32_bf16 v212, v209, v59, v212
  v_dot2_f32_bf16 v213, v211, v59, v213
  v_mul_f32 v204, v204, v206
  v_mul_f32 v205, v205, v207
  v_cvt_pk_bf16_f32 v198, v205, v204
  ds_write_b32 v15, v198 offset:768
  s_lshl_b32 s36, s35, 4
  v_add_u32 v6, s36, v4
  v_mul_f32 v212, v212, v214
  v_mul_f32 v213, v213, v215
  v_cvt_pk_bf16_f32 v199, v213, v212
  ds_write_b32 v15, v199 offset:896
  v_lshlrev_b32 v7, 7, v6
  v_lshl_add_u32 v7, v3, 4, v7
  v_add_u32 v24, 131072, v7
  v_lshlrev_b32 v8, 12, v6
  s_lshl_b32 s37, s35, 1
  v_xor_b32 v9, s37, v3
  v_lshl_add_u32 v25, v9, 4, v8
  s_add_u32 s37, s37, 1
  v_xor_b32 v10, s37, v3
  v_lshl_add_u32 v10, v10, 4, v8
  v_add_u32 v26, 0x8000, v10
  s_waitcnt lgkmcnt(0)
  s_barrier
  ds_read_b128 v[16:19], v24
  ds_read_b128 v[20:23], v24 offset:1024
  s_lshl_b32 s83, s33, 18
  s_lshl_b32 s84, s34, 7
  s_sub_u32 s83, s83, s84
  s_add_u32 s83, s83, 3968
  s_waitcnt lgkmcnt(1)
  buffer_store_dwordx4 v[16:19], v25, s[60:63], s83 offen sc1
  s_waitcnt lgkmcnt(0)
  buffer_store_dwordx4 v[20:23], v26, s[60:63], s83 offen sc1
  v_mov_b32 v253, 0
  buffer_load_dwordx2 v[250:251], v253, s[92:95], 0 offen sc1
  s_mov_b32 s75, 0x3f803f80
  v_mov_b32 v200, 0
  v_mov_b32 v208, 0
  v_mov_b32 v201, 0
  v_mov_b32 v209, 0
  v_mov_b32 v204, 0
  v_mov_b32 v210, 0
  v_mov_b32 v205, 0
  v_mov_b32 v211, 0
  s_waitcnt vmcnt(34)
  v_dot2_f32_bf16 v208, v128, s75, v208
  v_dot2_f32_bf16 v209, v128, v128, v209
  v_dot2_f32_bf16 v200, v129, s75, v200
  v_dot2_f32_bf16 v201, v129, v129, v201
  v_dot2_f32_bf16 v208, v130, s75, v208
  v_dot2_f32_bf16 v209, v130, v130, v209
  v_dot2_f32_bf16 v200, v131, s75, v200
  v_dot2_f32_bf16 v201, v131, v131, v201
  s_waitcnt vmcnt(26)
  v_dot2_f32_bf16 v210, v160, s75, v210
  v_dot2_f32_bf16 v211, v160, v160, v211
  v_dot2_f32_bf16 v204, v161, s75, v204
  v_dot2_f32_bf16 v205, v161, v161, v205
  v_dot2_f32_bf16 v210, v162, s75, v210
  v_dot2_f32_bf16 v211, v162, v162, v211
  v_dot2_f32_bf16 v204, v163, s75, v204
  v_dot2_f32_bf16 v205, v163, v163, v205
  v_dot2_f32_bf16 v208, v132, s75, v208
  v_dot2_f32_bf16 v209, v132, v132, v209
  v_dot2_f32_bf16 v200, v133, s75, v200
  v_dot2_f32_bf16 v201, v133, v133, v201
  v_dot2_f32_bf16 v208, v134, s75, v208
  v_dot2_f32_bf16 v209, v134, v134, v209
  v_dot2_f32_bf16 v200, v135, s75, v200
  v_dot2_f32_bf16 v201, v135, v135, v201
  s_waitcnt vmcnt(25)
  v_dot2_f32_bf16 v210, v164, s75, v210
  v_dot2_f32_bf16 v211, v164, v164, v211
  v_dot2_f32_bf16 v204, v165, s75, v204
  v_dot2_f32_bf16 v205, v165, v165, v205
  v_dot2_f32_bf16 v210, v166, s75, v210
  v_dot2_f32_bf16 v211, v166, v166, v211
  v_dot2_f32_bf16 v204, v167, s75, v204
  v_dot2_f32_bf16 v205, v167, v167, v205
  v_dot2_f32_bf16 v208, v136, s75, v208
  v_dot2_f32_bf16 v209, v136, v136, v209
  v_dot2_f32_bf16 v200, v137, s75, v200
  v_dot2_f32_bf16 v201, v137, v137, v201
  v_dot2_f32_bf16 v208, v138, s75, v208
  v_dot2_f32_bf16 v209, v138, v138, v209
  v_dot2_f32_bf16 v200, v139, s75, v200
  v_dot2_f32_bf16 v201, v139, v139, v201
  s_waitcnt vmcnt(24)
  v_dot2_f32_bf16 v210, v168, s75, v210
  v_dot2_f32_bf16 v211, v168, v168, v211
  v_dot2_f32_bf16 v204, v169, s75, v204
  v_dot2_f32_bf16 v205, v169, v169, v205
  v_dot2_f32_bf16 v210, v170, s75, v210
  v_dot2_f32_bf16 v211, v170, v170, v211
  v_dot2_f32_bf16 v204, v171, s75, v204
  v_dot2_f32_bf16 v205, v171, v171, v205
  v_dot2_f32_bf16 v208, v140, s75, v208
  v_dot2_f32_bf16 v209, v140, v140, v209
  v_dot2_f32_bf16 v200, v141, s75, v200
  v_dot2_f32_bf16 v201, v141, v141, v201
  v_dot2_f32_bf16 v208, v142, s75, v208
  v_dot2_f32_bf16 v209, v142, v142, v209
  v_dot2_f32_bf16 v200, v143, s75, v200
  v_dot2_f32_bf16 v201, v143, v143, v201
  s_waitcnt vmcnt(23)
  v_dot2_f32_bf16 v210, v172, s75, v210
  v_dot2_f32_bf16 v211, v172, v172, v211
  v_dot2_f32_bf16 v204, v173, s75, v204
  v_dot2_f32_bf16 v205, v173, v173, v205
  v_dot2_f32_bf16 v210, v174, s75, v210
  v_dot2_f32_bf16 v211, v174, v174, v211
  v_dot2_f32_bf16 v204, v175, s75, v204
  v_dot2_f32_bf16 v205, v175, v175, v205
  v_dot2_f32_bf16 v208, v144, s75, v208
  v_dot2_f32_bf16 v209, v144, v144, v209
  v_dot2_f32_bf16 v200, v145, s75, v200
  v_dot2_f32_bf16 v201, v145, v145, v201
  v_dot2_f32_bf16 v208, v146, s75, v208
  v_dot2_f32_bf16 v209, v146, v146, v209
  v_dot2_f32_bf16 v200, v147, s75, v200
  v_dot2_f32_bf16 v201, v147, v147, v201
  s_waitcnt vmcnt(22)
  v_dot2_f32_bf16 v210, v176, s75, v210
  v_dot2_f32_bf16 v211, v176, v176, v211
  v_dot2_f32_bf16 v204, v177, s75, v204
  v_dot2_f32_bf16 v205, v177, v177, v205
  v_dot2_f32_bf16 v210, v178, s75, v210
  v_dot2_f32_bf16 v211, v178, v178, v211
  v_dot2_f32_bf16 v204, v179, s75, v204
  v_dot2_f32_bf16 v205, v179, v179, v205
  v_dot2_f32_bf16 v208, v148, s75, v208
  v_dot2_f32_bf16 v209, v148, v148, v209
  v_dot2_f32_bf16 v200, v149, s75, v200
  v_dot2_f32_bf16 v201, v149, v149, v201
  v_dot2_f32_bf16 v208, v150, s75, v208
  v_dot2_f32_bf16 v209, v150, v150, v209
  v_dot2_f32_bf16 v200, v151, s75, v200
  v_dot2_f32_bf16 v201, v151, v151, v201
  s_waitcnt vmcnt(21)
  v_dot2_f32_bf16 v210, v180, s75, v210
  v_dot2_f32_bf16 v211, v180, v180, v211
  v_dot2_f32_bf16 v204, v181, s75, v204
  v_dot2_f32_bf16 v205, v181, v181, v205
  v_dot2_f32_bf16 v210, v182, s75, v210
  v_dot2_f32_bf16 v211, v182, v182, v211
  v_dot2_f32_bf16 v204, v183, s75, v204
  v_dot2_f32_bf16 v205, v183, v183, v205
  v_dot2_f32_bf16 v208, v152, s75, v208
  v_dot2_f32_bf16 v209, v152, v152, v209
  v_dot2_f32_bf16 v200, v153, s75, v200
  v_dot2_f32_bf16 v201, v153, v153, v201
  v_dot2_f32_bf16 v208, v154, s75, v208
  v_dot2_f32_bf16 v209, v154, v154, v209
  v_dot2_f32_bf16 v200, v155, s75, v200
  v_dot2_f32_bf16 v201, v155, v155, v201
  s_waitcnt vmcnt(20)
  v_dot2_f32_bf16 v210, v184, s75, v210
  v_dot2_f32_bf16 v211, v184, v184, v211
  v_dot2_f32_bf16 v204, v185, s75, v204
  v_dot2_f32_bf16 v205, v185, v185, v205
  v_dot2_f32_bf16 v210, v186, s75, v210
  v_dot2_f32_bf16 v211, v186, v186, v211
  v_dot2_f32_bf16 v204, v187, s75, v204
  v_dot2_f32_bf16 v205, v187, v187, v205
  v_dot2_f32_bf16 v208, v156, s75, v208
  v_dot2_f32_bf16 v209, v156, v156, v209
  v_dot2_f32_bf16 v200, v157, s75, v200
  v_dot2_f32_bf16 v201, v157, v157, v201
  v_dot2_f32_bf16 v208, v158, s75, v208
  v_dot2_f32_bf16 v209, v158, v158, v209
  v_dot2_f32_bf16 v200, v159, s75, v200
  v_dot2_f32_bf16 v201, v159, v159, v201
  s_waitcnt vmcnt(19)
  v_dot2_f32_bf16 v210, v188, s75, v210
  v_dot2_f32_bf16 v211, v188, v188, v211
  v_dot2_f32_bf16 v204, v189, s75, v204
  v_dot2_f32_bf16 v205, v189, v189, v205
  v_dot2_f32_bf16 v210, v190, s75, v210
  v_dot2_f32_bf16 v211, v190, v190, v211
  v_dot2_f32_bf16 v204, v191, s75, v204
  v_dot2_f32_bf16 v205, v191, v191, v205
  v_add_f32 v200, v200, v208
  v_add_f32 v201, v201, v209
  v_add_f32 v204, v204, v210
  v_add_f32 v205, v205, v211
  v_add_f32_dpp v200, v200, v200 quad_perm:[1,0,3,2] row_mask:0xf bank_mask:0xf
  v_add_f32_dpp v201, v201, v201 quad_perm:[1,0,3,2] row_mask:0xf bank_mask:0xf
  v_add_f32_dpp v204, v204, v204 quad_perm:[1,0,3,2] row_mask:0xf bank_mask:0xf
  v_add_f32_dpp v205, v205, v205 quad_perm:[1,0,3,2] row_mask:0xf bank_mask:0xf
  v_add_f32_dpp v200, v200, v200 quad_perm:[2,3,0,1] row_mask:0xf bank_mask:0xf
  v_add_f32_dpp v201, v201, v201 quad_perm:[2,3,0,1] row_mask:0xf bank_mask:0xf
  v_add_f32_dpp v204, v204, v204 quad_perm:[2,3,0,1] row_mask:0xf bank_mask:0xf
  v_add_f32_dpp v205, v205, v205 quad_perm:[2,3,0,1] row_mask:0xf bank_mask:0xf
  v_add_f32_dpp v200, v200, v200 row_half_mirror row_mask:0xf bank_mask:0xf
  v_add_f32_dpp v201, v201, v201 row_half_mirror row_mask:0xf bank_mask:0xf
  v_add_f32_dpp v204, v204, v204 row_half_mirror row_mask:0xf bank_mask:0xf
  v_add_f32_dpp v205, v205, v205 row_half_mirror row_mask:0xf bank_mask:0xf
  v_mul_f32 v200, 0x3b000000, v200
  v_mul_f32 v201, 0x3b000000, v201
  v_mul_f32 v204, 0x3b000000, v204
  v_mul_f32 v205, 0x3b000000, v205
  v_fma_f32 v201, -v200, v200, v201
  v_fma_f32 v205, -v204, v204, v205
  v_max_f32 v201, 0, v201
  v_max_f32 v205, 0, v205
  v_add_f32 v201, 0x3727c5ac, v201
  v_add_f32 v205, 0x3727c5ac, v205
  v_rsq_f32 v201, v201
  v_rsq_f32 v205, v205
  s_waitcnt vmcnt(0)
  v_readfirstlane_b32 s36, v251
  v_readfirstlane_b32 s32, v250
  s_nop 0
  s_cmp_eq_u32 s36, 0
  s_cbranch_scc0 Ln7_ok
  s_mov_b32 s79, 0
Ln7_loop:
  s_sleep 2
  buffer_load_dwordx2 v[250:251], v253, s[92:95], 0 offen sc1
  s_waitcnt vmcnt(0)
  v_readfirstlane_b32 s36, v251
  v_readfirstlane_b32 s32, v250
  s_add_u32 s79, s79, 1
  s_cmp_lg_u32 s36, 0
  s_cbranch_scc1 Ln7_ok
  s_cmp_lt_u32 s79, 0x40000
  s_cbranch_scc1 Ln7_loop
Ln7_ok:
  v_mov_b32 v202, v201
  v_mov_b32 v206, v205
  v_mov_b32 v201, s32
  v_mov_b32 v203, s32
  v_mov_b32 v205, s32
  v_mov_b32 v207, s32
  v_lshrrev_b32 v10, 3, v1
  v_lshlrev_b32 v10, 4, v10
  s_lshl_b32 s36, s73, 4
  s_mov_b32 exec_lo, 0x01010101
  s_mov_b32 exec_hi, 0x01010101
  buffer_store_dwordx4 v[200:203], v10, s[64:67], s36 offen sc1
  buffer_store_dwordx4 v[204:207], v10, s[64:67], s36 offen offset:128 sc1
  s_mov_b64 exec, -1
  s_mov_b32 s76, 0x00003f80
  s_mov_b32 s77, 0x3f800000
  v_dot2_f32_bf16 v216, v64, s76, 0
  v_dot2_f32_bf16 v217, v64, s77, 0
  v_dot2_f32_bf16 v218, v65, s76, 0
  v_dot2_f32_bf16 v219, v65, s77, 0
  v_dot2_f32_bf16 v220, v66, s76, 0
  v_dot2_f32_bf16 v221, v66, s77, 0
  v_dot2_f32_bf16 v222, v67, s76, 0
  v_dot2_f32_bf16 v223, v67, s77, 0
  v_dot2_f32_bf16 v224, v68, s76, 0
  v_dot2_f32_bf16 v225, v68, s77, 0
  v_dot2_f32_bf16 v226, v69, s76, 0
  v_dot2_f32_bf16 v227, v69, s77, 0
  v_dot2_f32_bf16 v228, v70, s76, 0
  v_dot2_f32_bf16 v229, v70, s77, 0
  v_dot2_f32_bf16 v230, v71, s76, 0
  v_dot2_f32_bf16 v231, v71, s77, 0
  v_dot2_f32_bf16 v216, v72, s76, v216
  v_dot2_f32_bf16 v217, v72, s77, v217
  v_dot2_f32_bf16 v218, v73, s76, v218
  v_dot2_f32_bf16 v219, v73, s77, v219
  v_dot2_f32_bf16 v220, v74, s76, v220
  v_dot2_f32_bf16 v221, v74, s77, v221
  v_dot2_f32_bf16 v222, v75, s76, v222
  v_dot2_f32_bf16 v223, v75, s77, v223
  v_dot2_f32_bf16 v224, v76, s76, v224
  v_dot2_f32_bf16 v225, v76, s77, v225
  v_dot2_f32_bf16 v226, v77, s76, v226
  v_dot2_f32_bf16 v227, v77, s77, v227
  v_dot2_f32_bf16 v228, v78, s76, v228
  v_dot2_f32_bf16 v229, v78, s77, v229
  v_dot2_f32_bf16 v230, v79, s76, v230
  v_dot2_f32_bf16 v231, v79, s77, v231
  v_dot2_f32_bf16 v216, v80, s76, v216
  v_dot2_f32_bf16 v217, v80, s77, v217
  v_dot2_f32_bf16 v218, v81, s76, v218
  v_dot2_f32_bf16 v219, v81, s77, v219
  v_dot2_f32_bf16 v220, v82, s76, v220
  v_dot2_f32_bf16 v221, v82, s77, v221
  v_dot2_f32_bf16 v222, v83, s76, v222
  v_dot2_f32_bf16 v223, v83, s77, v223
  v_dot2_f32_bf16 v224, v84, s76, v224
  v_dot2_f32_bf16 v225, v84, s77, v225
  v_dot2_f32_bf16 v226, v85, s76, v226
  v_dot2_f32_bf16 v227, v85, s77, v227
  v_dot2_f32_bf16 v228, v86, s76, v228
  v_dot2_f32_bf16 v229, v86, s77, v229
  v_dot2_f32_bf16 v230, v87, s76, v230
  v_dot2_f32_bf16 v231, v87, s77, v231
  v_dot2_f32_bf16 v216, v88, s76, v216
  v_dot2_f32_bf16 v217, v88, s77, v217
  v_dot2_f32_bf16 v218, v89, s76, v218
  v_dot2_f32_bf16 v219, v89, s77, v219
  v_dot2_f32_bf16 v220, v90, s76, v220
  v_dot2_f32_bf16 v221, v90, s77, v221
  v_dot2_f32_bf16 v222, v91, s76, v222
  v_dot2_f32_bf16 v223, v91, s77, v223
  v_dot2_f32_bf16 v224, v92, s76, v224
  v_dot2_f32_bf16 v225, v92, s77, v225
  v_dot2_f32_bf16 v226, v93, s76, v226
  v_dot2_f32_bf16 v227, v93, s77, v227
  v_dot2_f32_bf16 v228, v94, s76, v228
  v_dot2_f32_bf16 v229, v94, s77, v229
  v_dot2_f32_bf16 v230, v95, s76, v230
  v_dot2_f32_bf16 v231, v95, s77, v231
  v_dot2_f32_bf16 v216, v96, s76, v216
  v_dot2_f32_bf16 v217, v96, s77, v217
  v_dot2_f32_bf16 v218, v97, s76, v218
  v_dot2_f32_bf16 v219, v97, s77, v219
  v_dot2_f32_bf16 v220, v98, s76, v220
  v_dot2_f32_bf16 v221, v98, s77, v221
  v_dot2_f32_bf16 v222, v99, s76, v222
  v_dot2_f32_bf16 v223, v99, s77, v223
  v_dot2_f32_bf16 v224, v100, s76, v224
  v_dot2_f32_bf16 v225, v100, s77, v225
  v_dot2_f32_bf16 v226, v101, s76, v226
  v_dot2_f32_bf16 v227, v101, s77, v227
  v_dot2_f32_bf16 v228, v102, s76, v228
  v_dot2_f32_bf16 v229, v102, s77, v229
  v_dot2_f32_bf16 v230, v103, s76, v230
  v_dot2_f32_bf16 v231, v103, s77, v231
  v_dot2_f32_bf16 v216, v104, s76, v216
  v_dot2_f32_bf16 v217, v104, s77, v217
  v_dot2_f32_bf16 v218, v105, s76, v218
  v_dot2_f32_bf16 v219, v105, s77, v219
  v_dot2_f32_bf16 v220, v106, s76, v220
  v_dot2_f32_bf16 v221, v106, s77, v221
  v_dot2_f32_bf16 v222, v107, s76, v222
  v_dot2_f32_bf16 v223, v107, s77, v223
  v_dot2_f32_bf16 v224, v108, s76, v224
  v_dot2_f32_bf16 v225, v108, s77, v225
  v_dot2_f32_bf16 v226, v109, s76, v226
  v_dot2_f32_bf16 v227, v109, s77, v227
  v_dot2_f32_bf16 v228, v110, s76, v228
  v_dot2_f32_bf16 v229, v110, s77, v229
  v_dot2_f32_bf16 v230, v111, s76, v230
  v_dot2_f32_bf16 v231, v111, s77, v231
  v_dot2_f32_bf16 v216, v112, s76, v216
  v_dot2_f32_bf16 v217, v112, s77, v217
  v_dot2_f32_bf16 v218, v113, s76, v218
  v_dot2_f32_bf16 v219, v113, s77, v219
  v_dot2_f32_bf16 v220, v114, s76, v220
  v_dot2_f32_bf16 v221, v114, s77, v221
  v_dot2_f32_bf16 v222, v115, s76, v222
  v_dot2_f32_bf16 v223, v115, s77, v223
  v_dot2_f32_bf16 v224, v116, s76, v224
  v_dot2_f32_bf16 v225, v116, s77, v225
  v_dot2_f32_bf16 v226, v117, s76, v226
  v_dot2_f32_bf16 v227, v117, s77, v227
  v_dot2_f32_bf16 v228, v118, s76, v228
  v_dot2_f32_bf16 v229, v118, s77, v229
  v_dot2_f32_bf16 v230, v119, s76, v230
  v_dot2_f32_bf16 v231, v119, s77, v231
  v_dot2_f32_bf16 v216, v120, s76, v216
  v_dot2_f32_bf16 v217, v120, s77, v217
  v_dot2_f32_bf16 v218, v121, s76, v218
  v_dot2_f32_bf16 v219, v121, s77, v219
  v_dot2_f32_bf16 v220, v122, s76, v220
  v_dot2_f32_bf16 v221, v122, s77, v221
  v_dot2_f32_bf16 v222, v123, s76, v222
  v_dot2_f32_bf16 v223, v123, s77, v223
  v_dot2_f32_bf16 v224, v124, s76, v224
  v_dot2_f32_bf16 v225, v124, s77, v225
  v_dot2_f32_bf16 v226, v125, s76, v226
  v_dot2_f32_bf16 v227, v125, s77, v227
  v_dot2_f32_bf16 v228, v126, s76, v228
  v_dot2_f32_bf16 v229, v126, s77, v229
  v_dot2_f32_bf16 v230, v127, s76, v230
  v_dot2_f32_bf16 v231, v127, s77, v231
  v_lshlrev_b32 v10, 5, v1
  s_lshl_b32 s36, s35, 12
  v_add_u32 v10, s36, v10
  ds_write_b128 v10, v[216:219] offset:0
  ds_write_b128 v10, v[220:223] offset:16
  ds_write_b128 v10, v[224:227] offset:2048
  ds_write_b128 v10, v[228:231] offset:2064
  s_waitcnt lgkmcnt(0)
  s_barrier
  s_cmp_eq_u32 s35, 0
  s_cbranch_scc0 sp_nofk
  s_lshl_b32 s36, s33, 5
  s_add_u32 s36, s36, s34
  s_lshl_b32 s36, s36, 7
  v_mov_b32 v252, s32
  v_mov_b32 v253, 0
  s_mov_b64 exec, 1
  buffer_store_dword v252, v253, s[96:99], s36 offen sc1
  s_mov_b64 exec, -1
sp_nofk:
  v_lshlrev_b32 v10, 4, v0
  ds_read_b128 v[64:67], v10 offset:0
  ds_read_b128 v[68:71], v10 offset:4096
  ds_read_b128 v[72:75], v10 offset:8192
  ds_read_b128 v[76:79], v10 offset:12288
  s_waitcnt lgkmcnt(2)
  v_add_f32 v64, v64, v68
  s_waitcnt lgkmcnt(0)
  v_add_f32 v72, v72, v76
  v_add_f32 v65, v65, v69
  v_add_f32 v73, v73, v77
  v_add_f32 v66, v66, v70
  v_add_f32 v74, v74, v78
  v_add_f32 v67, v67, v71
  v_add_f32 v75, v75, v79
  v_add_f32 v80, v64, v72
  v_mov_b32 v81, s32
  v_add_f32 v82, v65, v73
  v_mov_b32 v83, s32
  v_add_f32 v84, v66, v74
  v_mov_b32 v85, s32
  v_add_f32 v86, v67, v75
  v_mov_b32 v87, s32
  s_mul_i32 s36, s74, 14336
  s_and_b32 s37, s33, 1
  s_mul_i32 s37, s37, 7168
  s_add_u32 s36, s36, s37
  v_lshlrev_b32 v11, 5, v0
  v_cmp_gt_u32 vcc, 224, v0
  s_nop 1
  v_cndmask_b32 v11, v253, v11, vcc
  v_mov_b32 v12, 0x7f000000
  v_cndmask_b32 v11, v12, v11, vcc
  buffer_store_dwordx4 v[80:83], v11, s[68:71], s36 offen sc1
  buffer_store_dwordx4 v[84:87], v11, s[68:71], s36 offen offset:16 sc1
  s_waitcnt lgkmcnt(0)
  s_barrier
  s_mov_b32 s8, s22
  s_mov_b32 s9, s23
  s_mov_b32 s10, 0x1c0000
  s_mov_b32 s11, 0x20000
  s_lshl_b32 s17, s35, 11
  s_lshr_b32 s89, s33, 1
  s_lshl_b32 s89, s89, 9
  s_lshr_b32 s36, s34, 2
  s_lshl_b32 s36, s36, 6
  s_add_u32 s89, s89, s36
  s_and_b32 s90, s33, 1
  s_lshl_b32 s90, s90, 2
  s_and_b32 s36, s34, 3
  s_add_u32 s90, s90, s36
  s_lshl_b32 s90, s90, 6
  s_lshr_b32 s36, s89, 5
  s_mul_i32 s36, s36, 112
  s_mul_i32 s37, s35, 28
  s_add_u32 s36, s36, s37
  s_lshl_b32 s91, s36, 10
  s_lshl_b32 s3, s37, 14
  s_lshl_b32 s36, s90, 1
  s_add_u32 s3, s3, s36
  v_lshlrev_b32 v244, 4, v1
  v_add_u32 v245, 114688, v244
  v_lshrrev_b32 v10, 3, v1
  v_and_b32 v11, 7, v1
  v_lshrrev_b32 v12, 1, v10
  v_and_b32 v12, 1, v12
  v_lshlrev_b32 v12, 2, v12
  v_xor_b32 v12, v12, v11
  v_lshlrev_b32 v12, 4, v12
  v_lshl_add_u32 v246, v10, 10, v12
  v_add_u32 v247, 7168, v246
  v_lshrrev_b32 v8, 2, v1
  v_and_b32 v9, 3, v1
  v_lshlrev_b32 v9, 7, v9
  v_lshl_add_u32 v9, v8, 10, v9
  s_lshl_b32 s83, s34, 2
  s_add_u32 s83, s83, s35
  s_mul_i32 s83, s83, 14336
  s_and_b32 s84, s33, 1
  s_lshl_b32 s84, s84, 9
  s_add_u32 s83, s83, s84
  s_mov_b32 exec_lo, 0xffffffff
  s_mov_b32 exec_hi, 0xffffff
  buffer_load_dword v186, v9, s[8:11], s83 offen
  s_mov_b64 exec, -1
  s_add_u32 m0, s17, 0
  s_add_u32 s75, s3, 196608
  buffer_load_dwordx4 v246, s[8:11], s75 offen lds
  buffer_load_dwordx4 v247, s[8:11], s75 offen offset:1024 lds
  s_add_u32 m0, s17, 8192
  s_add_u32 s75, s3, 212992
  buffer_load_dwordx4 v246, s[8:11], s75 offen lds
  buffer_load_dwordx4 v247, s[8:11], s75 offen offset:1024 lds
  s_add_u32 m0, s17, 16384
  s_add_u32 s75, s3, 229376
  buffer_load_dwordx4 v246, s[8:11], s75 offen lds
  buffer_load_dwordx4 v247, s[8:11], s75 offen offset:1024 lds
  s_add_u32 m0, s17, 24576
  s_add_u32 s75, s3, 245760
  buffer_load_dwordx4 v246, s[8:11], s75 offen lds
  buffer_load_dwordx4 v247, s[8:11], s75 offen offset:1024 lds
  s_add_u32 m0, s17, 32768
  s_add_u32 s75, s3, 262144
  buffer_load_dwordx4 v246, s[8:11], s75 offen lds
  buffer_load_dwordx4 v247, s[8:11], s75 offen offset:1024 lds
  s_add_u32 m0, s17, 40960
  s_add_u32 s75, s3, 278528
  buffer_load_dwordx4 v246, s[8:11], s75 offen lds
  buffer_load_dwordx4 v247, s[8:11], s75 offen offset:1024 lds
  s_add_u32 m0, s17, 49152
  s_add_u32 s75, s3, 294912
  buffer_load_dwordx4 v246, s[8:11], s75 offen lds
  buffer_load_dwordx4 v247, s[8:11], s75 offen offset:1024 lds
  s_add_u32 m0, s17, 57344
  s_add_u32 s75, s3, 311296
  buffer_load_dwordx4 v246, s[8:11], s75 offen lds
  buffer_load_dwordx4 v247, s[8:11], s75 offen offset:1024 lds
  s_add_u32 m0, s17, 65536
  s_add_u32 s75, s3, 327680
  buffer_load_dwordx4 v246, s[8:11], s75 offen lds
  buffer_load_dwordx4 v247, s[8:11], s75 offen offset:1024 lds
  s_add_u32 m0, s17, 73728
  s_add_u32 s75, s3, 344064
  buffer_load_dwordx4 v246, s[8:11], s75 offen lds
  buffer_load_dwordx4 v247, s[8:11], s75 offen offset:1024 lds
  s_add_u32 m0, s17, 81920
  s_add_u32 s75, s3, 360448
  buffer_load_dwordx4 v246, s[8:11], s75 offen lds
  buffer_load_dwordx4 v247, s[8:11], s75 offen offset:1024 lds
  s_add_u32 m0, s17, 90112
  s_add_u32 s75, s3, 376832
  buffer_load_dwordx4 v246, s[8:11], s75 offen lds
  buffer_load_dwordx4 v247, s[8:11], s75 offen offset:1024 lds
  s_add_u32 s48, s30, 0x800000
  s_addc_u32 s49, s31, 0
  s_mov_b32 s50, 0x200000
  s_mov_b32 s51, 0x20000
  s_mov_b32 s44, s12
  s_mov_b32 s45, s13
  s_mov_b32 s46, 0x200000
  s_mov_b32 s47, 0x20000
  s_mov_b32 s60, s14
  s_mov_b32 s61, s15
  s_mov_b32 s62, 0x400
  s_mov_b32 s63, 0x20000
  s_lshr_b32 s36, s35, 1
  s_and_b32 s87, s35, 1
  s_lshl_b32 s86, s33, 6
  s_lshl_b32 s37, s34, 1
  s_add_u32 s86, s86, s37
  s_add_u32 s86, s86, s36
  s_mul_i32 s88, s36, 21248
  s_add_u32 s88, s88, 98560
  v_min_u32 v185, 31, v1
  v_lshlrev_b32 v185, 7, v185
  s_lshl_b32 s85, s33, 12
  buffer_load_dword v184, v185, s[96:99], s85 offen sc1
  s_waitcnt vmcnt(0) lgkmcnt(0)
  v_cmp_ne_u32 vcc, s32, v184
  s_nop 4
  s_cbranch_vccz Lp8_ok
  s_mov_b32 s79, 0
Lp8_loop:
  s_sleep 2
  buffer_load_dword v184, v185, s[96:99], s85 offen sc1
  s_waitcnt vmcnt(0)
  v_cmp_ne_u32 vcc, s32, v184
  s_nop 4
  s_cbranch_vccz Lp8_ok
  s_add_u32 s79, s79, 1
  s_cmp_lt_u32 s79, 0x40000
  s_cbranch_scc1 Lp8_loop
Lp8_ok:
  s_lshl_b32 s83, s86, 12
  s_lshl_b32 s84, s87, 11
  s_add_u32 s83, s83, s84
  v_lshlrev_b32 v2, 4, v1
  buffer_load_dwordx4 v[220:223], v2, s[48:51], s83 offen offset:0 sc1
  buffer_load_dwordx4 v[224:227], v2, s[48:51], s83 offen offset:4 sc1
  buffer_load_dwordx4 v[228:231], v2, s[48:51], s83 offen offset:8 sc1
  buffer_load_dwordx4 v[232:235], v2, s[48:51], s83 offen offset:1024 sc1
  buffer_load_dwordx4 v[236:239], v2, s[48:51], s83 offen offset:1028 sc1
  buffer_load_dwordx4 v[240:243], v2, s[48:51], s83 offen offset:1032 sc1
  v_mov_b32 v4, 0
  s_lshl_b32 s84, s86, 1
  buffer_load_ushort v254, v4, s[60:63], s84 offen
  s_lshl_b32 s36, s86, 12
  s_lshl_b32 s37, s87, 11
  s_add_u32 s36, s36, s37
  v_lshlrev_b32 v2, 4, v1
  s_add_u32 s38, s88, s37
  s_add_u32 m0, s38, 17152
  s_add_u32 s38, s36, 0
  buffer_load_dwordx4 v2, s[44:47], s38 offen lds
  s_add_u32 s38, s88, s37
  s_add_u32 m0, s38, 18176
  s_add_u32 s38, s36, 1024
  buffer_load_dwordx4 v2, s[44:47], s38 offen lds
  v_mov_b32 v16, 0
  v_mov_b32 v17, 0
  v_mov_b32 v18, 0
  v_mov_b32 v19, 0
  v_lshrrev_b32 v5, 1, v1
  v_mul_u32_u24 v5, 4160, v5
  v_and_b32 v6, 1, v1
  v_lshl_add_u32 v5, v6, 4, v5
  v_add_u32 v5, 4096, v5
  v_add_u32 v6, 16640, v2
  s_cmp_eq_u32 s87, 0
  s_cselect_b32 s76, 0xff, -1
  s_cselect_b64 vcc, -1, 0
  v_cndmask_b32 v5, v6, v5, vcc
  v_add_u32 v5, s88, v5
  s_mov_b32 exec_lo, s76
  s_mov_b32 exec_hi, 0
  ds_write_b128 v5, v[16:19]
  s_mov_b64 exec, -1
  s_waitcnt vmcnt(0)
  v_mov_b32 v13, 163832
  ds_write_b32 v13, v253
  v_lshlrev_b32 v2, 4, v1
  v_mov_b32 v8, 0
  s_lshl_b32 s77, s87, 31
  s_mov_b32 s76, 0
  v_cndmask_b32 v239, v239, v8, s[76:77]
  v_cndmask_b32 v242, v242, v8, s[76:77]
  v_cndmask_b32 v243, v243, v8, s[76:77]
  s_lshl_b32 s37, s87, 11
  s_add_u32 s37, s37, s88
  v_add_u32 v5, s37, v2
  ds_write_b128 v5, v[220:223] offset:0
  v_alignbit_b32 v16, v224, v220, 16
  v_alignbit_b32 v17, v225, v221, 16
  v_alignbit_b32 v18, v226, v222, 16
  v_alignbit_b32 v19, v227, v223, 16
  ds_write_b128 v5, v[224:227] offset:8320
  v_alignbit_b32 v20, v228, v224, 16
  v_alignbit_b32 v21, v229, v225, 16
  v_alignbit_b32 v22, v230, v226, 16
  v_alignbit_b32 v23, v231, v227, 16
  ds_write_b128 v5, v[16:19] offset:4160
  ds_write_b128 v5, v[20:23] offset:12480
  ds_write_b128 v5, v[232:235] offset:1024
  v_alignbit_b32 v24, v236, v232, 16
  v_alignbit_b32 v25, v237, v233, 16
  v_alignbit_b32 v26, v238, v234, 16
  v_alignbit_b32 v27, v239, v235, 16
  ds_write_b128 v5, v[236:239] offset:9344
  v_alignbit_b32 v28, v240, v236, 16
  v_alignbit_b32 v29, v241, v237, 16
  v_alignbit_b32 v30, v242, v238, 16
  v_alignbit_b32 v31, v243, v239, 16
  ds_write_b128 v5, v[24:27] offset:5184
  ds_write_b128 v5, v[28:31] offset:13504
  s_branch fz_cfill
fz_end:
  s_endpgm
.section .rodata,"a"
.p2align 6
.amdhsa_kernel parallel_sum__ssm_conv_h3__dense_activation_squared_relu__prompt_kernel
  .amdhsa_next_free_vgpr 512
  .amdhsa_next_free_sgpr 102
  .amdhsa_accum_offset 256
  .amdhsa_group_segment_fixed_size 0
  .amdhsa_kernarg_size 112
  .amdhsa_user_sgpr_count 2
  .amdhsa_user_sgpr_kernarg_segment_ptr 1
  .amdhsa_system_sgpr_workgroup_id_x 1
  .amdhsa_float_denorm_mode_32 3
.end_amdhsa_kernel
```
